```python
import torch

def _softmax(x, axis=-1):
    return torch.softmax(x, dim=axis)
def _gelu(x):
    return torch.nn.functional.gelu(x, approximate="tanh")
def _silu(x):
    return torch.nn.functional.silu(x)
def _sigmoid(x):
    return torch.sigmoid(x)
def _layernorm(x, axis=-1, eps=1e-5):
    m = x.mean(dim=axis, keepdim=True)
    v = x.var(dim=axis, keepdim=True, unbiased=False)
    return (x - m) / torch.sqrt(v + eps)
def _scatter_add(tgt, idx, src, axis=0):
    return tgt.clone().index_add_(axis, idx, src)
def _segment_sum(src, seg, n):
    out = torch.zeros((n,) + src.shape[1:], dtype=src.dtype)
    return out.index_add_(0, seg, src)
def _pad(x, pw):
    flat = tuple(v for pair in reversed(pw) for v in pair)
    return torch.nn.functional.pad(x, flat)

kernel_name = 'sequential_preLN__softmax_full_mha__glu_gated_reglu__prompt'

def setup_inputs():

    _w = (lambda a: (lambda t: t.to(torch.bfloat16) if t.is_floating_point() else t)(torch.as_tensor(a)))
    def _A_setup():
        B, S, D = 1, 2048, 512
        return {
            "x": _w((lambda *s: torch.randn(*s, dtype=torch.bfloat16) * 0.05)(B, S, D)),
            "wqkv": _w((lambda *s: torch.randn(*s, dtype=torch.bfloat16) * 0.05)(D, 3 * D)),
            "wo": _w((lambda *s: torch.randn(*s, dtype=torch.bfloat16) * 0.05)(D, D)),
        }
    _A_in = _A_setup()

    def _B_setup():
        B, S, D, F = 1, 2048, 512, 1376
        return {
            "x": _w((lambda *s: torch.randn(*s, dtype=torch.bfloat16) * 0.05)(B, S, D)),
            "W_gate": _w((lambda *s: torch.randn(*s, dtype=torch.bfloat16) * 0.4)(D, F) * (2.0 / D) ** 0.5),
            "W_up": _w((lambda *s: torch.randn(*s, dtype=torch.bfloat16) * 0.4)(D, F) * (2.0 / D) ** 0.5),
            "W_down": _w((lambda *s: torch.randn(*s, dtype=torch.bfloat16) * 0.4)(F, D) * (1.0 / F) ** 0.5),
        }
    _B_in = _B_setup()

    return {
        "A_x": _A_in["x"],
        "A_wqkv": _A_in["wqkv"],
        "A_wo": _A_in["wo"],
        "B_x": _B_in["x"],
        "B_W_gate": _B_in["W_gate"],
        "B_W_up": _B_in["W_up"],
        "B_W_down": _B_in["W_down"],
    }

def reference(A_x, A_wqkv, A_wo, B_x, B_W_gate, B_W_up, B_W_down):
    def _A_ref(x, wqkv, wo):
        B, S, D = x.shape
        H = 32; Dh = D // H
        qkv = (lambda x, *d: x.permute(*d))((x @ wqkv).reshape(B, S, 3, H, Dh), 2, 0, 3, 1, 4)
        q, k, v = qkv[0], qkv[1], qkv[2]
        scale = Dh ** -0.5
        scores = torch.einsum("bhqd,bhkd->bhqk", q, k) * scale
        p = _softmax(scores, axis=-1)
        o = torch.einsum("bhqk,bhkd->bhqd", p, v)
        return (lambda x, *d: x.permute(*d))(o, 0, 2, 1, 3).reshape(B, S, D) @ wo

    def _B_ref(x, W_gate, W_up, W_down):
        gate = torch.einsum("bsd,df->bsf", x, W_gate)
        up = torch.einsum("bsd,df->bsf", x, W_up)
        gate = gate * (lambda x, dt: x.to(dt))(gate > 0, gate.dtype)
        h = gate * up
        return torch.einsum("bsf,fd->bsd", h, W_down)

    x = A_x
    h = x + _A_ref(_layernorm(x, axis=-1), A_wqkv, A_wo)
    h2 = h + _B_ref(_layernorm(h, axis=-1), B_W_gate, B_W_up, B_W_down)
    return h2
```

```asm
; @launch grid=(256,1,1) block=(512,1,1) lds=163840
.amdgcn_target "amdgcn-amd-amdhsa--gfx950"
.text
.globl sequential_preLN__softmax_full_mha__glu_gated_reglu__prompt_kernel
.p2align 8
.type sequential_preLN__softmax_full_mha__glu_gated_reglu__prompt_kernel,@function
sequential_preLN__softmax_full_mha__glu_gated_reglu__prompt_kernel:
    s_cmp_ge_u32 s2, 256
    s_cbranch_scc1 L_done
    s_load_dwordx16 s[64:79], s[0:1], 0
    s_load_dwordx2 s[6:7], s[0:1], 72
    s_and_b32 s40, s2, 7
    s_lshr_b32 s41, s2, 3
    v_lshrrev_b32 v3, 6, v0
    v_and_b32 v1, 63, v0
    v_readfirstlane_b32 s42, v3
    v_lshlrev_b32 v2, 4, v1
    s_cmp_lt_u32 s42, 4
    s_cbranch_scc1 L_p1_compute
    v_lshrrev_b32 v5, 3, v1
    v_and_b32 v6, 7, v1
    v_lshrrev_b32 v7, 4, v1
    v_xor_b32 v100, v6, v7
    v_xor_b32 v101, 4, v100
    v_lshlrev_b32 v100, 4, v100
    v_lshlrev_b32 v101, 4, v101
    v_lshl_add_u32 v100, v5, 10, v100
    v_lshl_add_u32 v101, v5, 10, v101
    s_sub_u32 s46, s42, 4
    s_lshl_b32 s44, s41, 16
    s_lshl_b32 s45, s46, 14
    s_add_u32 s44, s44, s45
    v_add_u32 v100, s44, v100
    s_add_u32 s44, s44, 8192
    v_add_u32 v101, s44, v101
    v_and_b32 v7, 1, v7
    v_lshlrev_b32 v7, 2, v7
    v_xor_b32 v6, v6, v7
    v_lshlrev_b32 v6, 4, v6
    v_mul_u32_u24 v102, 3072, v5
    v_add_u32 v102, v102, v6
    s_mul_i32 s44, s46, 49152
    s_lshl_b32 s45, s40, 7
    s_add_u32 s44, s44, s45
    v_add_u32 v102, s44, v102
    s_lshl_b32 s51, s46, 11
    s_add_u32 s48, s40, s41
    s_waitcnt lgkmcnt(0)
    s_mov_b32 s8, s64
    s_and_b32 s9, s65, 0xffff
    s_mov_b32 s10, 0x200000
    s_mov_b32 s11, 0x20000
    s_mov_b32 s12, s66
    s_and_b32 s13, s67, 0xffff
    s_mov_b32 s14, 0x180000
    s_mov_b32 s15, 0x20000
    s_add_u32 s46, s48, 0
    s_and_b32 s46, s46, 7
    s_add_u32 m0, s51, 0
    s_lshl_b32 s44, s46, 7
    s_mul_i32 s46, s46, 196608
    buffer_load_dwordx4 v100, s[8:11], s44 offen lds
    s_add_u32 m0, s51, 1024
    s_nop 0
    buffer_load_dwordx4 v101, s[8:11], s44 offen lds
    s_add_u32 m0, s51, 8192
    s_add_u32 s44, s46, 0
    buffer_load_dwordx4 v102, s[12:15], s44 offen lds
    s_add_u32 m0, s51, 9216
    s_add_u32 s44, s46, 24576
    buffer_load_dwordx4 v102, s[12:15], s44 offen lds
    s_add_u32 m0, s51, 16384
    s_add_u32 s44, s46, 1024
    buffer_load_dwordx4 v102, s[12:15], s44 offen lds
    s_add_u32 m0, s51, 17408
    s_add_u32 s44, s46, 25600
    buffer_load_dwordx4 v102, s[12:15], s44 offen lds
    s_add_u32 m0, s51, 24576
    s_add_u32 s44, s46, 2048
    buffer_load_dwordx4 v102, s[12:15], s44 offen lds
    s_add_u32 m0, s51, 25600
    s_add_u32 s44, s46, 26624
    buffer_load_dwordx4 v102, s[12:15], s44 offen lds
    s_add_u32 s46, s48, 1
    s_and_b32 s46, s46, 7
    s_add_u32 m0, s51, 32768
    s_lshl_b32 s44, s46, 7
    s_mul_i32 s46, s46, 196608
    buffer_load_dwordx4 v100, s[8:11], s44 offen lds
    s_add_u32 m0, s51, 33792
    s_nop 0
    buffer_load_dwordx4 v101, s[8:11], s44 offen lds
    s_add_u32 m0, s51, 40960
    s_add_u32 s44, s46, 0
    buffer_load_dwordx4 v102, s[12:15], s44 offen lds
    s_add_u32 m0, s51, 41984
    s_add_u32 s44, s46, 24576
    buffer_load_dwordx4 v102, s[12:15], s44 offen lds
    s_add_u32 m0, s51, 49152
    s_add_u32 s44, s46, 1024
    buffer_load_dwordx4 v102, s[12:15], s44 offen lds
    s_add_u32 m0, s51, 50176
    s_add_u32 s44, s46, 25600
    buffer_load_dwordx4 v102, s[12:15], s44 offen lds
    s_add_u32 m0, s51, 57344
    s_add_u32 s44, s46, 2048
    buffer_load_dwordx4 v102, s[12:15], s44 offen lds
    s_add_u32 m0, s51, 58368
    s_add_u32 s44, s46, 26624
    buffer_load_dwordx4 v102, s[12:15], s44 offen lds
    s_mov_b32 s16, s6
    s_and_b32 s17, s7, 0xffff
    s_mov_b32 s18, 0x1800000
    s_mov_b32 s19, 0x20000
    s_mov_b32 s20, s68
    s_and_b32 s21, s69, 0xffff
    s_mov_b32 s22, 0x80000
    s_mov_b32 s23, 0x20000
    s_mov_b32 s28, s76
    s_and_b32 s29, s77, 0xffff
    s_mov_b32 s30, 0x158000
    s_mov_b32 s31, 0x20000
    s_mov_b32 s32, s78
    s_and_b32 s33, s79, 0xffff
    s_mov_b32 s34, 0x200000
    s_mov_b32 s35, 0x20000
    s_and_b32 s44, s42, 1
    s_cmp_eq_u32 s44, 0
    s_cselect_b32 s72, s72, s74
    s_cselect_b32 s73, s73, s75
    s_mov_b32 s24, s72
    s_and_b32 s25, s73, 0xffff
    s_mov_b32 s26, 0x158000
    s_mov_b32 s27, 0x20000
    s_add_u32 s6, s6, 0x1108000
    s_addc_u32 s7, s7, 0
    s_load_dword s43, s[6:7], 0
    v_and_b32 v105, 31, v1
    v_lshlrev_b32 v105, 2, v105
    s_lshl_b32 s49, s40, 8
    s_add_u32 s49, s49, 0x1102000
    s_waitcnt vmcnt(8)
    s_barrier
    s_waitcnt lgkmcnt(0)
    s_add_u32 s43, s43, 1
    s_getreg_b32 s44, hwreg(HW_REG_XCC_ID, 0, 4)
    s_lshl_b32 s50, s43, 4
    s_or_b32 s50, s50, s44
    s_add_u32 s46, s48, 2
    s_and_b32 s46, s46, 7
    s_add_u32 m0, s51, 65536
    s_lshl_b32 s44, s46, 7
    s_mul_i32 s46, s46, 196608
    buffer_load_dwordx4 v100, s[8:11], s44 offen lds
    s_add_u32 m0, s51, 66560
    s_nop 0
    buffer_load_dwordx4 v101, s[8:11], s44 offen lds
    s_add_u32 m0, s51, 73728
    s_add_u32 s44, s46, 0
    buffer_load_dwordx4 v102, s[12:15], s44 offen lds
    s_add_u32 m0, s51, 74752
    s_add_u32 s44, s46, 24576
    buffer_load_dwordx4 v102, s[12:15], s44 offen lds
    s_add_u32 m0, s51, 81920
    s_add_u32 s44, s46, 1024
    buffer_load_dwordx4 v102, s[12:15], s44 offen lds
    s_add_u32 m0, s51, 82944
    s_add_u32 s44, s46, 25600
    buffer_load_dwordx4 v102, s[12:15], s44 offen lds
    s_add_u32 m0, s51, 90112
    s_add_u32 s44, s46, 2048
    buffer_load_dwordx4 v102, s[12:15], s44 offen lds
    s_add_u32 m0, s51, 91136
    s_add_u32 s44, s46, 26624
    buffer_load_dwordx4 v102, s[12:15], s44 offen lds
    s_waitcnt vmcnt(8)
    s_barrier
    s_add_u32 s46, s48, 3
    s_and_b32 s46, s46, 7
    s_add_u32 m0, s51, 98304
    s_lshl_b32 s44, s46, 7
    s_mul_i32 s46, s46, 196608
    buffer_load_dwordx4 v100, s[8:11], s44 offen lds
    s_add_u32 m0, s51, 99328
    s_nop 0
    buffer_load_dwordx4 v101, s[8:11], s44 offen lds
    s_add_u32 m0, s51, 106496
    s_add_u32 s44, s46, 0
    buffer_load_dwordx4 v102, s[12:15], s44 offen lds
    s_add_u32 m0, s51, 107520
    s_add_u32 s44, s46, 24576
    buffer_load_dwordx4 v102, s[12:15], s44 offen lds
    s_add_u32 m0, s51, 114688
    s_add_u32 s44, s46, 1024
    buffer_load_dwordx4 v102, s[12:15], s44 offen lds
    s_add_u32 m0, s51, 115712
    s_add_u32 s44, s46, 25600
    buffer_load_dwordx4 v102, s[12:15], s44 offen lds
    s_add_u32 m0, s51, 122880
    s_add_u32 s44, s46, 2048
    buffer_load_dwordx4 v102, s[12:15], s44 offen lds
    s_add_u32 m0, s51, 123904
    s_add_u32 s44, s46, 26624
    buffer_load_dwordx4 v102, s[12:15], s44 offen lds
    s_waitcnt vmcnt(8)
    s_barrier
    s_add_u32 s46, s48, 4
    s_and_b32 s46, s46, 7
    s_add_u32 m0, s51, 0
    s_lshl_b32 s44, s46, 7
    s_mul_i32 s46, s46, 196608
    buffer_load_dwordx4 v100, s[8:11], s44 offen lds
    s_add_u32 m0, s51, 1024
    s_nop 0
    buffer_load_dwordx4 v101, s[8:11], s44 offen lds
    s_add_u32 m0, s51, 8192
    s_add_u32 s44, s46, 0
    buffer_load_dwordx4 v102, s[12:15], s44 offen lds
    s_add_u32 m0, s51, 9216
    s_add_u32 s44, s46, 24576
    buffer_load_dwordx4 v102, s[12:15], s44 offen lds
    s_add_u32 m0, s51, 16384
    s_add_u32 s44, s46, 1024
    buffer_load_dwordx4 v102, s[12:15], s44 offen lds
    s_add_u32 m0, s51, 17408
    s_add_u32 s44, s46, 25600
    buffer_load_dwordx4 v102, s[12:15], s44 offen lds
    s_add_u32 m0, s51, 24576
    s_add_u32 s44, s46, 2048
    buffer_load_dwordx4 v102, s[12:15], s44 offen lds
    s_add_u32 m0, s51, 25600
    s_add_u32 s44, s46, 26624
    buffer_load_dwordx4 v102, s[12:15], s44 offen lds
    s_waitcnt vmcnt(8)
    s_barrier
    s_add_u32 s46, s48, 5
    s_and_b32 s46, s46, 7
    s_add_u32 m0, s51, 32768
    s_lshl_b32 s44, s46, 7
    s_mul_i32 s46, s46, 196608
    buffer_load_dwordx4 v100, s[8:11], s44 offen lds
    s_add_u32 m0, s51, 33792
    s_nop 0
    buffer_load_dwordx4 v101, s[8:11], s44 offen lds
    s_add_u32 m0, s51, 40960
    s_add_u32 s44, s46, 0
    buffer_load_dwordx4 v102, s[12:15], s44 offen lds
    s_add_u32 m0, s51, 41984
    s_add_u32 s44, s46, 24576
    buffer_load_dwordx4 v102, s[12:15], s44 offen lds
    s_add_u32 m0, s51, 49152
    s_add_u32 s44, s46, 1024
    buffer_load_dwordx4 v102, s[12:15], s44 offen lds
    s_add_u32 m0, s51, 50176
    s_add_u32 s44, s46, 25600
    buffer_load_dwordx4 v102, s[12:15], s44 offen lds
    s_add_u32 m0, s51, 57344
    s_add_u32 s44, s46, 2048
    buffer_load_dwordx4 v102, s[12:15], s44 offen lds
    s_add_u32 m0, s51, 58368
    s_add_u32 s44, s46, 26624
    buffer_load_dwordx4 v102, s[12:15], s44 offen lds
    s_waitcnt vmcnt(8)
    s_barrier
    s_add_u32 s46, s48, 6
    s_and_b32 s46, s46, 7
    s_add_u32 m0, s51, 65536
    s_lshl_b32 s44, s46, 7
    s_mul_i32 s46, s46, 196608
    buffer_load_dwordx4 v100, s[8:11], s44 offen lds
    s_add_u32 m0, s51, 66560
    s_nop 0
    buffer_load_dwordx4 v101, s[8:11], s44 offen lds
    s_add_u32 m0, s51, 73728
    s_add_u32 s44, s46, 0
    buffer_load_dwordx4 v102, s[12:15], s44 offen lds
    s_add_u32 m0, s51, 74752
    s_add_u32 s44, s46, 24576
    buffer_load_dwordx4 v102, s[12:15], s44 offen lds
    s_add_u32 m0, s51, 81920
    s_add_u32 s44, s46, 1024
    buffer_load_dwordx4 v102, s[12:15], s44 offen lds
    s_add_u32 m0, s51, 82944
    s_add_u32 s44, s46, 25600
    buffer_load_dwordx4 v102, s[12:15], s44 offen lds
    s_add_u32 m0, s51, 90112
    s_add_u32 s44, s46, 2048
    buffer_load_dwordx4 v102, s[12:15], s44 offen lds
    s_add_u32 m0, s51, 91136
    s_add_u32 s44, s46, 26624
    buffer_load_dwordx4 v102, s[12:15], s44 offen lds
    s_waitcnt vmcnt(8)
    s_barrier
    s_add_u32 s46, s48, 7
    s_and_b32 s46, s46, 7
    s_add_u32 m0, s51, 98304
    s_lshl_b32 s44, s46, 7
    s_mul_i32 s46, s46, 196608
    buffer_load_dwordx4 v100, s[8:11], s44 offen lds
    s_add_u32 m0, s51, 99328
    s_nop 0
    buffer_load_dwordx4 v101, s[8:11], s44 offen lds
    s_add_u32 m0, s51, 106496
    s_add_u32 s44, s46, 0
    buffer_load_dwordx4 v102, s[12:15], s44 offen lds
    s_add_u32 m0, s51, 107520
    s_add_u32 s44, s46, 24576
    buffer_load_dwordx4 v102, s[12:15], s44 offen lds
    s_add_u32 m0, s51, 114688
    s_add_u32 s44, s46, 1024
    buffer_load_dwordx4 v102, s[12:15], s44 offen lds
    s_add_u32 m0, s51, 115712
    s_add_u32 s44, s46, 25600
    buffer_load_dwordx4 v102, s[12:15], s44 offen lds
    s_add_u32 m0, s51, 122880
    s_add_u32 s44, s46, 2048
    buffer_load_dwordx4 v102, s[12:15], s44 offen lds
    s_add_u32 m0, s51, 123904
    s_add_u32 s44, s46, 26624
    buffer_load_dwordx4 v102, s[12:15], s44 offen lds
    s_waitcnt vmcnt(8)
    s_barrier
    buffer_load_dword v104, v105, s[16:19], s49 offen sc0 sc1
    s_sub_u32 s46, s42, 4
    s_mul_i32 s44, s40, 0xc0000
    s_lshl_b32 s46, s46, 16
    s_add_u32 s44, s44, s46
    s_lshl_b32 s45, s41, 11
    s_add_u32 s44, s44, s45
    s_add_u32 s45, s44, 0x0
    buffer_load_dwordx4 v[164:167], v2, s[16:19], s45 offen
    buffer_load_dwordx4 v[164:167], v2, s[16:19], s45 offen offset:1024
    s_waitcnt vmcnt(3)
    s_barrier
    s_barrier
    s_cmp_lg_u32 s42, 7
    s_cbranch_scc1 L_pl_skip
    s_mov_b32 s45, 200000
    s_waitcnt vmcnt(2)
L_pl_loop:
    v_xor_b32 v103, s50, v104
    v_cmp_lt_u32 vcc, 15, v103
    s_cbranch_vccz L_pl_ok
    s_sub_u32 s45, s45, 1
    s_cbranch_scc1 L_pl_ok
    buffer_load_dword v104, v105, s[16:19], s49 offen sc0 sc1
    s_waitcnt vmcnt(0)
    s_branch L_pl_loop
L_pl_ok:
    v_cmp_ne_u32 vcc, 0, v103
    v_mov_b32 v3, 135680
    s_nop 3
    s_cmp_eq_u64 vcc, 0
    s_cselect_b32 s44, 1, 0
    v_mov_b32 v103, s44
    ds_write_b32 v3, v103
    s_waitcnt lgkmcnt(0)
L_pl_skip:
    s_barrier
    v_mov_b32 v103, 135680
    ds_read_b32 v106, v103
    s_lshl_b32 s44, s40, 2
    s_and_b32 s46, s41, 3
    s_add_u32 s64, s46, s44
    s_lshr_b32 s45, s41, 3
    s_add_u32 s70, s44, s45
    s_and_b32 s71, s41, 7
    s_and_b32 s72, s42, 1
    s_lshr_b32 s73, s42, 1
    s_lshl_b32 s68, s42, 10
    s_lshl_b32 s69, s42, 13
    s_mul_i32 s47, s40, 0xc0000
    s_lshl_b32 s46, s46, 16
    s_add_u32 s67, s47, s46
    s_lshl_b32 s45, s73, 14
    s_add_u32 s66, s67, s45
    s_mul_i32 s44, s72, 131072
    s_add_u32 s78, s45, s44
    s_lshr_b32 s45, s41, 2
    s_lshl_b32 s65, s45, 3
    s_lshl_b32 s44, s72, 2
    s_add_u32 s65, s65, s44
    s_add_u32 s65, s65, s73
    s_lshl_b32 s37, s40, 8
    s_add_u32 s37, s37, 0x1100000
    s_lshl_b32 s44, s41, 2
    s_add_u32 s36, s37, s44
    s_lshl_b32 s45, s45, 8
    s_and_b32 s44, s41, 3
    s_lshl_b32 s44, s44, 3
    s_add_u32 s44, s44, s40
    s_lshl_b32 s44, s44, 2
    s_add_u32 s38, s45, s44
    s_add_u32 s38, s38, 0x1100800
    v_lshrrev_b32 v6, 5, v1
    v_and_b32 v5, 15, v1
    v_lshlrev_b32 v5, 4, v5
    v_lshl_add_u32 v240, v6, 8, v5
    v_mov_b32 v241, 0xdddd
    s_lshl_b32 s45, s72, 2
    v_lshrrev_b32 v5, 1, v1
    v_xor_b32 v5, s45, v5
    v_mul_u32_u24 v10, 2752, v5
    v_and_b32 v6, 1, v1
    v_lshl_add_u32 v10, v6, 4, v10
    s_mul_i32 s44, s41, 96
    v_add_u32 v10, s44, v10
    s_mul_i32 s75, s73, 88064
    s_mul_i32 s74, s73, 6144
    s_lshl_b32 s44, s72, 10
    s_add_u32 s74, s74, s44
    s_add_u32 s74, s74, 65536
    s_lshl_b32 s76, s73, 17
    s_lshl_b32 s44, s40, 3
    s_add_u32 s44, s44, s42
    s_lshl_b32 s83, s44, 15
    s_add_u32 s54, s83, 0
    s_add_u32 s55, s83, 8192
    s_add_u32 s56, s83, 16384
    s_add_u32 s57, s83, 24576
    s_lshl_b32 s84, s44, 11
    s_add_u32 s84, s84, 0xa00000
    s_mov_b32 s90, 0xffff
    s_mov_b32 s91, 0xffff
    s_xor_b32 s44, s69, 16384
    s_add_u32 s44, s44, 0
    v_add_u32 v12, s44, v2
    s_xor_b32 s44, s69, 32768
    s_add_u32 s44, s44, 2304
    v_add_u32 v13, s44, v2
    s_xor_b32 s44, s69, 49152
    s_add_u32 s44, s44, 4608
    v_add_u32 v14, s44, v2
    v_add_u32 v15, s69, v2
    v_and_b32 v5, 15, v1
    v_bfe_u32 v6, v1, 4, 1
    v_cmp_eq_u32 vcc, v5, v6
    v_mov_b32 v5, 0x3f803f80
    s_nop 1
    v_cndmask_b32 v252, 0, v5, vcc
    v_mov_b32 v253, v252
    v_mov_b32 v254, v252
    v_mov_b32 v255, v252
    s_mul_i32 s47, s40, 0xc0000
    s_lshl_b32 s44, s65, 5
    s_add_u32 s44, s44, s64
    s_lshl_b32 s44, s44, 10
    s_add_u32 s86, s44, 0x600000
    s_mul_i32 s44, s42, 86
    s_mul_i32 s45, s41, 3
    s_add_u32 s44, s44, s45
    s_lshl_b32 s44, s44, 10
    s_add_u32 s79, s44, s47
    s_lshl_b32 s46, s70, 1
    s_add_u32 s46, s46, s72
    s_and_b32 s44, s46, 7
    s_mul_i32 s44, s44, 86
    s_add_u32 s44, s44, s73
    s_lshl_b32 s44, s44, 10
    s_add_u32 s85, s44, s47
    s_cmp_lt_u32 s73, 2
    s_cselect_b32 s87, 0, 0x40000000
    s_lshl_b32 s47, s46, 5
    s_lshl_b32 s45, s73, 3
    s_add_u32 s44, s47, s45
    s_lshl_b32 s44, s44, 10
    s_add_u32 s82, s44, 0x600000
    s_and_b32 s44, s73, 1
    s_lshl_b32 s44, s44, 1
    s_lshr_b32 s45, s73, 1
    s_add_u32 s88, s44, s45
    s_lshl_b32 s45, s71, 2
    s_add_u32 s44, s88, s45
    s_add_u32 s44, s44, s47
    s_lshl_b32 s80, s46, 15
    s_lshl_b32 s44, s88, 13
    s_add_u32 s80, s80, s44
    s_lshl_b32 s44, s71, 7
    s_add_u32 s80, s80, s44
    s_lshl_b32 s44, s46, 3
    s_add_u32 s44, s44, s71
    s_lshl_b32 s44, s44, 8
    s_add_u32 s81, s44, 0xa00000
    v_and_b32 v5, 31, v1
    v_lshrrev_b32 v6, 5, v1
    s_lshl_b32 s44, s46, 15
    s_lshl_b32 s45, s71, 7
    s_add_u32 s44, s44, s45
    s_lshl_b32 s47, s88, 5
    s_add_u32 s44, s44, s47
    v_lshlrev_b32 v7, 10, v5
    v_lshl_add_u32 v7, v6, 4, v7
    v_add_u32 v249, s44, v7
    v_lshlrev_b32 v7, 3, v5
    v_lshl_add_u32 v248, v6, 2, v7
    v_lshl_add_u32 v250, v6, 10, v7
    v_lshl_add_u32 v251, v1, 2, s69
    s_lshl_b32 s44, s70, 16
    s_add_u32 s44, s44, s69
    s_add_u32 s77, s44, s45
    v_bfe_u32 v7, v1, 1, 3
    s_lshl_b32 s44, s88, 1
    v_xor_b32 v7, s44, v7
    v_lshlrev_b32 v7, 4, v7
    v_lshl_add_u32 v7, v6, 3, v7
    v_and_b32 v5, 7, v1
    v_lshl_add_u32 v7, v5, 7, v7
    v_bfe_u32 v247, v1, 3, 2
    v_lshl_add_u32 v7, v247, 13, v7
    s_lshl_b32 s44, s72, 15
    s_add_u32 s44, s44, 6912
    v_add_u32 v247, s44, v7
    v_lshrrev_b32 v7, 4, v1
    s_lshl_b32 s44, s72, 2
    v_xor_b32 v7, s44, v7
    v_xor_b32 v7, v5, v7
    v_lshlrev_b32 v7, 4, v7
    v_lshrrev_b32 v246, 3, v1
    v_lshl_add_u32 v246, v246, 10, v7
    v_lshrrev_b32 v7, 3, v1
    v_lshlrev_b32 v7, 10, v7
    v_lshl_add_u32 v175, v5, 4, v7
    v_bfe_u32 v7, v1, 4, 1
    v_lshlrev_b32 v11, 2, v7
    v_xor_b32 v11, v5, v11
    v_lshlrev_b32 v11, 4, v11
    v_lshrrev_b32 v5, 3, v1
    v_lshl_add_u32 v11, v5, 10, v11
    v_add_u32 v11, s45, v11
    v_bfe_u32 v5, v1, 2, 2
    v_xor_b32 v242, v6, v7
    v_lshl_add_u32 v242, v242, 2, v5
    v_lshlrev_b32 v242, 5, v242
    v_lshl_add_u32 v242, v7, 10, v242
    v_and_b32 v243, 3, v1
    v_lshl_add_u32 v242, v243, 3, v242
    v_lshl_add_u32 v5, v6, 2, v5
    v_lshlrev_b32 v5, 7, v5
    v_lshl_add_u32 v5, v243, 3, v5
    v_lshl_add_u32 v5, v7, 5, v5
    v_bfe_u32 v7, v1, 3, 1
    s_and_b32 s44, s73, 1
    v_xor_b32 v7, s44, v7
    v_lshl_add_u32 v8, v7, 6, v5
    v_xor_b32 v9, 64, v8
    v_add_u32 v243, 114688, v242
    v_add_u32 v242, 0x10000, v242
    s_lshl_b32 s44, s73, 14
    v_add_u32 v244, s44, v8
    v_add_u32 v245, s44, v9
    v_and_b32 v5, 27, v1
    v_cmp_eq_u32 vcc, 16, v5
    v_mov_b32 v6, 0x3f803f80
    s_nop 0
    v_cndmask_b32 v44, 0, v6, vcc
    v_mov_b32 v45, v44
    v_mov_b32 v46, v44
    v_mov_b32 v47, v44
    v_mov_b32 v48, v44
    v_mov_b32 v49, v44
    v_mov_b32 v50, v44
    v_mov_b32 v51, v44
    v_mov_b32 v52, v44
    v_mov_b32 v53, v44
    v_mov_b32 v54, v44
    v_mov_b32 v55, v44
    v_mov_b32 v56, v44
    v_mov_b32 v57, v44
    v_mov_b32 v58, v44
    v_mov_b32 v59, v44
    v_mov_b32 v60, v44
    v_mov_b32 v61, v44
    v_mov_b32 v62, v44
    v_mov_b32 v63, v44
    v_mov_b32 v64, v44
    v_mov_b32 v65, v44
    v_mov_b32 v66, v44
    v_mov_b32 v67, v44
    v_pk_mul_f32 v[176:177], 0, 0
    v_pk_mul_f32 v[178:179], 0, 0
    v_pk_mul_f32 v[180:181], 0, 0
    v_pk_mul_f32 v[182:183], 0, 0
    v_pk_mul_f32 v[184:185], 0, 0
    v_pk_mul_f32 v[186:187], 0, 0
    v_pk_mul_f32 v[188:189], 0, 0
    v_pk_mul_f32 v[190:191], 0, 0
    v_pk_mul_f32 v[192:193], 0, 0
    v_pk_mul_f32 v[194:195], 0, 0
    v_pk_mul_f32 v[196:197], 0, 0
    v_pk_mul_f32 v[198:199], 0, 0
    v_pk_mul_f32 v[200:201], 0, 0
    v_pk_mul_f32 v[202:203], 0, 0
    v_pk_mul_f32 v[204:205], 0, 0
    v_pk_mul_f32 v[206:207], 0, 0
    v_pk_mul_f32 v[208:209], 0, 0
    v_pk_mul_f32 v[210:211], 0, 0
    v_pk_mul_f32 v[212:213], 0, 0
    v_pk_mul_f32 v[214:215], 0, 0
    v_pk_mul_f32 v[216:217], 0, 0
    v_pk_mul_f32 v[218:219], 0, 0
    v_pk_mul_f32 v[220:221], 0, 0
    v_pk_mul_f32 v[222:223], 0, 0
    v_pk_mul_f32 v[224:225], 0, 0
    v_pk_mul_f32 v[226:227], 0, 0
    v_pk_mul_f32 v[228:229], 0, 0
    v_pk_mul_f32 v[230:231], 0, 0
    v_pk_mul_f32 v[232:233], 0, 0
    v_pk_mul_f32 v[234:235], 0, 0
    v_pk_mul_f32 v[236:237], 0, 0
    v_pk_mul_f32 v[238:239], 0, 0
    s_waitcnt lgkmcnt(0)
    v_readfirstlane_b32 s3, v106
    s_cmp_lg_u32 s42, 7
    s_cbranch_scc1 L_sig_1
    v_mov_b32 v4, s43
    v_lshlrev_b32 v3, 2, v1
    s_add_u32 s44, s36, 0
    s_cmp_eq_u32 s3, 0
    s_cbranch_scc1 L_sgl_2
    s_mov_b64 exec, 1
    s_waitcnt vmcnt(0)
    s_barrier
    buffer_store_dword v4, v3, s[16:19], s44 offen
    s_mov_b64 exec, -1
    s_branch L_sig_1_j
L_sgl_2:
    s_mov_b64 exec, 1
    s_waitcnt vmcnt(0)
    s_barrier
    buffer_store_dword v4, v3, s[16:19], s44 offen sc0 sc1
    s_mov_b64 exec, -1
    s_branch L_sig_1_j
L_sig_1:
    s_waitcnt vmcnt(0)
    s_barrier
L_sig_1_j:
    s_branch L_p1_join
L_p1_compute:
    s_waitcnt lgkmcnt(0)
    s_mov_b32 s8, s64
    s_and_b32 s9, s65, 0xffff
    s_mov_b32 s10, 0x200000
    s_mov_b32 s11, 0x20000
    s_mov_b32 s16, s6
    s_and_b32 s17, s7, 0xffff
    s_mov_b32 s18, 0x1800000
    s_mov_b32 s19, 0x20000
    s_mov_b32 s20, s68
    s_and_b32 s21, s69, 0xffff
    s_mov_b32 s22, 0x80000
    s_mov_b32 s23, 0x20000
    s_mov_b32 s28, s76
    s_and_b32 s29, s77, 0xffff
    s_mov_b32 s30, 0x158000
    s_mov_b32 s31, 0x20000
    s_mov_b32 s32, s78
    s_and_b32 s33, s79, 0xffff
    s_mov_b32 s34, 0x200000
    s_mov_b32 s35, 0x20000
    s_and_b32 s44, s42, 1
    s_cmp_eq_u32 s44, 0
    s_cselect_b32 s72, s72, s74
    s_cselect_b32 s73, s73, s75
    s_mov_b32 s24, s72
    s_and_b32 s25, s73, 0xffff
    s_mov_b32 s26, 0x158000
    s_mov_b32 s27, 0x20000
    s_add_u32 s6, s6, 0x1108000
    s_addc_u32 s7, s7, 0
    s_load_dword s43, s[6:7], 0
    s_lshl_b32 s44, s40, 2
    s_and_b32 s46, s41, 3
    s_add_u32 s64, s46, s44
    s_lshr_b32 s45, s41, 3
    s_add_u32 s70, s44, s45
    s_and_b32 s71, s41, 7
    s_and_b32 s72, s42, 1
    s_lshr_b32 s73, s42, 1
    s_lshl_b32 s68, s42, 10
    s_lshl_b32 s69, s42, 13
    s_mul_i32 s47, s40, 0xc0000
    s_lshl_b32 s46, s46, 16
    s_add_u32 s67, s47, s46
    s_lshl_b32 s45, s73, 14
    s_add_u32 s66, s67, s45
    s_mul_i32 s44, s72, 131072
    s_add_u32 s78, s45, s44
    s_lshr_b32 s45, s41, 2
    s_lshl_b32 s65, s45, 3
    s_lshl_b32 s44, s72, 2
    s_add_u32 s65, s65, s44
    s_add_u32 s65, s65, s73
    s_lshl_b32 s37, s40, 8
    s_add_u32 s37, s37, 0x1100000
    s_lshl_b32 s44, s41, 2
    s_add_u32 s36, s37, s44
    s_lshl_b32 s45, s45, 8
    s_and_b32 s44, s41, 3
    s_lshl_b32 s44, s44, 3
    s_add_u32 s44, s44, s40
    s_lshl_b32 s44, s44, 2
    s_add_u32 s38, s45, s44
    s_add_u32 s38, s38, 0x1100800
    v_lshrrev_b32 v6, 5, v1
    v_and_b32 v5, 15, v1
    v_lshlrev_b32 v5, 4, v5
    v_lshl_add_u32 v240, v6, 8, v5
    v_mov_b32 v241, 0xdddd
    s_lshl_b32 s45, s72, 2
    v_lshrrev_b32 v5, 1, v1
    v_xor_b32 v5, s45, v5
    v_mul_u32_u24 v10, 2752, v5
    v_and_b32 v6, 1, v1
    v_lshl_add_u32 v10, v6, 4, v10
    s_mul_i32 s44, s41, 96
    v_add_u32 v10, s44, v10
    s_mul_i32 s75, s73, 88064
    s_mul_i32 s74, s73, 6144
    s_lshl_b32 s44, s72, 10
    s_add_u32 s74, s74, s44
    s_add_u32 s74, s74, 65536
    s_lshl_b32 s76, s73, 17
    s_lshl_b32 s44, s40, 3
    s_add_u32 s44, s44, s42
    s_lshl_b32 s83, s44, 15
    s_add_u32 s54, s83, 0
    s_add_u32 s55, s83, 8192
    s_add_u32 s56, s83, 16384
    s_add_u32 s57, s83, 24576
    s_lshl_b32 s84, s44, 11
    s_add_u32 s84, s84, 0xa00000
    s_mov_b32 s90, 0xffff
    s_mov_b32 s91, 0xffff
    s_xor_b32 s44, s69, 16384
    s_add_u32 s44, s44, 0
    v_add_u32 v12, s44, v2
    s_xor_b32 s44, s69, 32768
    s_add_u32 s44, s44, 2304
    v_add_u32 v13, s44, v2
    s_xor_b32 s44, s69, 49152
    s_add_u32 s44, s44, 4608
    v_add_u32 v14, s44, v2
    v_add_u32 v15, s69, v2
    v_and_b32 v5, 15, v1
    v_bfe_u32 v6, v1, 4, 1
    v_cmp_eq_u32 vcc, v5, v6
    v_mov_b32 v5, 0x3f803f80
    s_nop 1
    v_cndmask_b32 v252, 0, v5, vcc
    v_mov_b32 v253, v252
    v_mov_b32 v254, v252
    v_mov_b32 v255, v252
    s_lshr_b32 s52, s42, 1
    v_and_b32 v5, 31, v1
    v_lshrrev_b32 v6, 5, v1
    v_bfe_u32 v7, v1, 1, 3
    v_xor_b32 v6, v6, v7
    s_lshl_b32 s44, s42, 1
    v_xor_b32 v6, s44, v6
    v_lshlrev_b32 v6, 4, v6
    v_lshl_add_u32 v6, v5, 7, v6
    s_lshl_b32 s44, s72, 12
    v_add_u32 v110, s44, v6
    v_xor_b32 v111, 32, v110
    v_xor_b32 v112, 64, v110
    v_xor_b32 v113, 96, v110
    v_bfe_u32 v5, v1, 2, 2
    v_lshrrev_b32 v6, 5, v1
    v_lshl_add_u32 v5, v6, 3, v5
    v_lshlrev_b32 v5, 7, v5
    v_and_b32 v6, 3, v1
    v_lshl_add_u32 v5, v6, 3, v5
    v_bfe_u32 v6, v1, 4, 1
    v_lshl_add_u32 v5, v6, 5, v5
    v_bfe_u32 v6, v1, 3, 1
    v_xor_b32 v6, s52, v6
    v_lshl_add_u32 v5, v6, 6, v5
    s_lshl_b32 s44, s42, 11
    s_add_u32 s44, s44, 8192
    v_add_u32 v114, s44, v5
    v_xor_b32 v115, 2048, v114
    v_xor_b32 v116, 4096, v114
    v_xor_b32 v117, 6144, v114
    v_mov_b32 v84, 0
    v_mov_b32 v85, 0
    v_mov_b32 v86, 0
    v_mov_b32 v87, 0
    v_mov_b32 v88, 0
    v_mov_b32 v89, 0
    v_mov_b32 v90, 0
    v_mov_b32 v91, 0
    v_mov_b32 v92, 0
    v_mov_b32 v93, 0
    v_mov_b32 v94, 0
    v_mov_b32 v95, 0
    v_mov_b32 v96, 0
    v_mov_b32 v97, 0
    v_mov_b32 v98, 0
    v_mov_b32 v99, 0
    v_mov_b32 v100, 0
    v_mov_b32 v101, 0
    v_mov_b32 v128, 0
    v_mov_b32 v129, 0
    v_mov_b32 v130, 0
    v_mov_b32 v131, 0
    v_mov_b32 v132, 0
    v_mov_b32 v133, 0
    v_mov_b32 v134, 0
    v_mov_b32 v135, 0
    v_mov_b32 v136, 0
    v_mov_b32 v137, 0
    v_mov_b32 v138, 0
    v_mov_b32 v139, 0
    v_mov_b32 v140, 0
    v_mov_b32 v141, 0
    v_mov_b32 v142, 0
    v_mov_b32 v143, 0
    v_mov_b32 v144, 0
    v_mov_b32 v145, 0
    v_mov_b32 v146, 0
    v_mov_b32 v147, 0
    v_mov_b32 v148, 0
    v_mov_b32 v149, 0
    v_mov_b32 v150, 0
    v_mov_b32 v151, 0
    v_mov_b32 v152, 0
    v_mov_b32 v153, 0
    v_mov_b32 v154, 0
    v_mov_b32 v155, 0
    v_mov_b32 v156, 0
    v_mov_b32 v157, 0
    v_mov_b32 v158, 0
    v_mov_b32 v159, 0
    v_mov_b32 v160, 0
    v_mov_b32 v161, 0
    v_mov_b32 v162, 0
    v_mov_b32 v163, 0
    v_mov_b32 v164, 0
    v_mov_b32 v165, 0
    v_mov_b32 v166, 0
    v_mov_b32 v167, 0
    v_mov_b32 v168, 0
    v_mov_b32 v169, 0
    v_mov_b32 v170, 0
    v_mov_b32 v171, 0
    v_mov_b32 v172, 0
    v_mov_b32 v173, 0
    v_mov_b32 v174, 0
    v_mov_b32 v175, 0
    v_and_b32 v7, 31, v1
    v_lshrrev_b32 v127, 5, v1
    s_lshl_b32 s44, s42, 7
    s_add_u32 s45, s44, 135168
    v_lshl_add_u32 v120, v7, 2, s45
    v_lshl_add_u32 v121, v127, 4, s45
    s_lshl_b32 s44, s72, 8
    s_add_u32 s44, s44, 131072
    v_lshl_add_u32 v118, v7, 2, s44
    s_mul_i32 s44, s52, 384
    s_add_u32 s44, s44, 132096
    v_lshl_add_u32 v119, v7, 2, s44
    s_lshl_b32 s44, s52, 9
    v_add_u32 v125, s44, v118
    s_mul_i32 s44, s72, 768
    v_add_u32 v126, s44, v119
    s_mul_i32 s44, s40, 0xc0000
    s_lshl_b32 s45, s52, 17
    s_add_u32 s44, s44, s45
    s_lshl_b32 s45, s41, 1
    s_add_u32 s45, s45, s72
    s_lshl_b32 s45, s45, 10
    s_add_u32 s44, s44, s45
    v_add_u32 v122, s44, v2
    v_and_b32 v5, 0x33, v1
    v_bfe_u32 v6, v1, 2, 1
    v_lshl_or_b32 v5, v6, 3, v5
    v_bfe_u32 v6, v1, 3, 1
    v_lshl_or_b32 v5, v6, 2, v5
    v_lshl_add_u32 v123, v5, 4, s44
    v_and_b32 v5, 15, v1
    v_lshlrev_b32 v5, 4, v5
    v_lshl_add_u32 v5, v127, 8, v5
    v_bfe_u32 v6, v1, 4, 1
    v_lshl_add_u32 v5, v6, 16, v5
    v_add_u32 v124, s44, v5
    s_cmp_lg_u32 s42, 0
    s_cbranch_scc1 L_nopub
    s_getreg_b32 s44, hwreg(HW_REG_XCC_ID, 0, 4)
    s_add_u32 s46, s36, 8192
    s_waitcnt lgkmcnt(0)
    s_add_u32 s45, s43, 1
    s_lshl_b32 s45, s45, 4
    s_or_b32 s45, s45, s44
    v_mov_b32 v4, s45
    v_mov_b32 v3, 0
    s_mov_b64 exec, 1
    buffer_store_dword v4, v3, s[16:19], s46 offen sc0 sc1
    s_mov_b64 exec, -1
L_nopub:
    s_cmp_lg_u32 s42, 1
    s_cbranch_scc1 L_noft
    v_lshlrev_b32 v3, 11, v1
    s_mov_b64 exec, 15
    buffer_load_dword v4, v3, s[16:19], s37 offen
    s_mov_b64 exec, -1
L_noft:
    s_waitcnt lgkmcnt(0)
    s_barrier
    ds_read_b128 v[20:23], v110
    ds_read_b64_tr_b16 v[24:25], v114 offset:0
    ds_read_b64_tr_b16 v[26:27], v114 offset:512
    ds_read_b64_tr_b16 v[28:29], v114 offset:8192
    ds_read_b64_tr_b16 v[30:31], v114 offset:8704
    ds_read_b64_tr_b16 v[32:33], v114 offset:16384
    ds_read_b64_tr_b16 v[34:35], v114 offset:16896
    ds_read_b128 v[36:39], v111
    ds_read_b64_tr_b16 v[40:41], v115 offset:0
    ds_read_b64_tr_b16 v[42:43], v115 offset:512
    ds_read_b64_tr_b16 v[44:45], v115 offset:8192
    ds_read_b64_tr_b16 v[46:47], v115 offset:8704
    ds_read_b64_tr_b16 v[48:49], v115 offset:16384
    ds_read_b64_tr_b16 v[50:51], v115 offset:16896
    s_mov_b32 s48, 0
L_p1_loop:
    s_waitcnt lgkmcnt(7)
    v_mfma_f32_32x32x16_bf16 v[128:143], v[24:27], v[20:23], v[128:143]
    ds_read_b128 v[52:55], v112
    ds_read_b64_tr_b16 v[56:57], v116 offset:0
    ds_read_b64_tr_b16 v[58:59], v116 offset:512
    s_add_u32 s44, s48, 1
    s_xor_b32 s45, s44, s48
    v_mfma_f32_32x32x16_bf16 v[144:159], v[28:31], v[20:23], v[144:159]
    ds_read_b64_tr_b16 v[60:61], v116 offset:8192
    ds_read_b64_tr_b16 v[62:63], v116 offset:8704
    s_and_b32 s45, s45, 3
    s_lshl_b32 s49, s45, 15
    s_mov_b32 s48, s44
    v_mfma_f32_32x32x16_bf16 v[160:175], v[20:23], v[32:35], v[160:175]
    ds_read_b64_tr_b16 v[64:65], v116 offset:16384
    ds_read_b64_tr_b16 v[66:67], v116 offset:16896
    v_xor_b32 v110, s49, v110
    v_xor_b32 v114, s49, v114
    v_xor_b32 v111, s49, v111
    v_xor_b32 v115, s49, v115
    v_mfma_f32_16x16x32_bf16 v[88:91], v[252:255], v[24:27], v[88:91]
    v_mfma_f32_16x16x32_bf16 v[92:95], v[252:255], v[28:31], v[92:95]
    v_mfma_f32_16x16x32_bf16 v[96:99], v[252:255], v[32:35], v[96:99]
    s_waitcnt lgkmcnt(7)
    v_mfma_f32_32x32x16_bf16 v[128:143], v[40:43], v[36:39], v[128:143]
    ds_read_b128 v[68:71], v113
    ds_read_b64_tr_b16 v[72:73], v117 offset:0
    v_lshlrev_b32 v102, 16, v36
    v_and_b32 v103, 0xffff0000, v36
    v_lshlrev_b32 v104, 16, v37
    v_and_b32 v105, 0xffff0000, v37
    v_mfma_f32_32x32x16_bf16 v[144:159], v[44:47], v[36:39], v[144:159]
    ds_read_b64_tr_b16 v[74:75], v117 offset:512
    ds_read_b64_tr_b16 v[76:77], v117 offset:8192
    v_lshlrev_b32 v106, 16, v38
    v_and_b32 v107, 0xffff0000, v38
    v_lshlrev_b32 v108, 16, v39
    v_and_b32 v109, 0xffff0000, v39
    v_mfma_f32_32x32x16_bf16 v[160:175], v[36:39], v[48:51], v[160:175]
    ds_read_b64_tr_b16 v[78:79], v117 offset:8704
    ds_read_b64_tr_b16 v[80:81], v117 offset:16384
    v_fmac_f32 v100, v102, v102
    v_fmac_f32 v101, v103, v103
    v_fmac_f32 v100, v104, v104
    v_fmac_f32 v101, v105, v105
    v_mfma_f32_16x16x32_bf16 v[84:87], v[252:255], v[36:39], v[84:87]
    ds_read_b64_tr_b16 v[82:83], v117 offset:16896
    v_fmac_f32 v100, v106, v106
    v_fmac_f32 v101, v107, v107
    v_fmac_f32 v100, v108, v108
    v_fmac_f32 v101, v109, v109
    s_waitcnt lgkmcnt(7)
    s_barrier
    v_mfma_f32_32x32x16_bf16 v[128:143], v[56:59], v[52:55], v[128:143]
    ds_read_b128 v[20:23], v110
    ds_read_b64_tr_b16 v[24:25], v114 offset:0
    v_lshlrev_b32 v102, 16, v52
    v_and_b32 v103, 0xffff0000, v52
    v_lshlrev_b32 v104, 16, v53
    v_and_b32 v105, 0xffff0000, v53
    v_mfma_f32_32x32x16_bf16 v[144:159], v[60:63], v[52:55], v[144:159]
    ds_read_b64_tr_b16 v[26:27], v114 offset:512
    ds_read_b64_tr_b16 v[28:29], v114 offset:8192
    v_lshlrev_b32 v106, 16, v54
    v_and_b32 v107, 0xffff0000, v54
    v_lshlrev_b32 v108, 16, v55
    v_and_b32 v109, 0xffff0000, v55
    v_mfma_f32_32x32x16_bf16 v[160:175], v[52:55], v[64:67], v[160:175]
    ds_read_b64_tr_b16 v[30:31], v114 offset:8704
    ds_read_b64_tr_b16 v[32:33], v114 offset:16384
    v_fmac_f32 v100, v102, v102
    v_fmac_f32 v101, v103, v103
    v_fmac_f32 v100, v104, v104
    v_fmac_f32 v101, v105, v105
    v_mfma_f32_16x16x32_bf16 v[84:87], v[252:255], v[52:55], v[84:87]
    ds_read_b64_tr_b16 v[34:35], v114 offset:16896
    v_fmac_f32 v100, v106, v106
    v_fmac_f32 v101, v107, v107
    v_fmac_f32 v100, v108, v108
    v_fmac_f32 v101, v109, v109
    s_waitcnt lgkmcnt(7)
    v_mfma_f32_32x32x16_bf16 v[128:143], v[72:75], v[68:71], v[128:143]
    ds_read_b128 v[36:39], v111
    ds_read_b64_tr_b16 v[40:41], v115 offset:0
    ds_read_b64_tr_b16 v[42:43], v115 offset:512
    v_mfma_f32_32x32x16_bf16 v[144:159], v[76:79], v[68:71], v[144:159]
    ds_read_b64_tr_b16 v[44:45], v115 offset:8192
    ds_read_b64_tr_b16 v[46:47], v115 offset:8704
    v_xor_b32 v112, s49, v112
    v_xor_b32 v116, s49, v116
    v_mfma_f32_32x32x16_bf16 v[160:175], v[68:71], v[80:83], v[160:175]
    ds_read_b64_tr_b16 v[48:49], v115 offset:16384
    ds_read_b64_tr_b16 v[50:51], v115 offset:16896
    v_xor_b32 v113, s49, v113
    v_xor_b32 v117, s49, v117
    s_cmp_lt_u32 s48, 8
    v_mfma_f32_16x16x32_bf16 v[88:91], v[252:255], v[72:75], v[88:91]
    v_mfma_f32_16x16x32_bf16 v[92:95], v[252:255], v[76:79], v[92:95]
    v_mfma_f32_16x16x32_bf16 v[96:99], v[252:255], v[80:83], v[96:99]
    s_cbranch_scc1 L_p1_loop
    v_add_f32 v100, v100, v101
    s_nop 0
    v_mov_b32 v101, v100
    s_nop 1
    v_permlane32_swap_b32 v100, v101
    s_mov_b64 exec, 0xffff
    ds_write2_b32 v125, v84, v85 offset0:0 offset1:16
    ds_write2_b32 v126, v88, v89 offset0:0 offset1:16
    ds_write2_b32 v126, v92, v93 offset0:32 offset1:48
    ds_write2_b32 v126, v96, v97 offset0:64 offset1:80
    s_mov_b64 exec, 0xffffffff
    v_add_f32 v100, v100, v101
    s_nop 0
    ds_write_b32 v125, v100 offset:128
    s_mov_b64 exec, -1
    v_mov_b32 v19, 135680
    v_cmp_gt_u32 vcc, 32, v1
    s_waitcnt lgkmcnt(0)
    s_barrier
    ds_read2_b32 v[20:21], v118 offset0:0 offset1:32
    ds_read2_b32 v[26:27], v118 offset0:128 offset1:160
    ds_read2_b32 v[22:23], v119 offset0:0 offset1:32
    ds_read2_b32 v[28:29], v119 offset0:192 offset1:224
    ds_read2st64_b32 v[24:25], v119 offset0:1 offset1:4
    ds_read_b32 v18, v19
    v_mov_b32 v86, 0
    v_mov_b32 v87, 0
    v_mov_b32 v90, 0
    v_mov_b32 v91, 0
    v_mov_b32 v94, 0
    v_mov_b32 v95, 0
    v_mov_b32 v98, 0
    v_mov_b32 v99, 0
    s_mov_b32 s45, 0x3b000000
    s_waitcnt lgkmcnt(4)
    v_pk_add_f32 v[20:21], v[20:21], v[26:27]
    s_nop 0
    v_mul_f32 v102, s45, v20
    v_mul_f32 v21, s45, v21
    v_fma_f32 v21, -v102, v102, v21
    v_cndmask_b32 v102, 0, -v102, vcc
    v_max_f32 v21, 0, v21
    v_cvt_pk_bf16_f32 v85, v102, v86
    v_add_f32 v21, 0x3727c5ac, v21
    v_lshlrev_b32 v103, 16, v85
    v_rsq_f32 v104, v21
    v_sub_f32 v103, v102, v103
    v_cvt_pk_bf16_f32 v84, v102, v103
    ds_write_b32 v120, v104
    s_waitcnt lgkmcnt(1)
    v_readfirstlane_b32 s3, v18
    v_pk_add_f32 v[22:23], v[22:23], v[28:29]
    v_add_f32 v24, v24, v25
    v_cndmask_b32 v23, 0, v23, vcc
    v_cvt_pk_bf16_f32 v92, v23, v23
    v_and_b32 v103, 0xffff0000, v92
    v_sub_f32 v103, v23, v103
    v_cvt_pk_bf16_f32 v93, v103, v86
    ds_read_b128 v[68:71], v121 offset:0
    ds_read_b128 v[72:75], v121 offset:32
    ds_read_b128 v[76:79], v121 offset:64
    ds_read_b128 v[80:83], v121 offset:96
    v_mfma_f32_32x32x16_bf16 v[144:159], v[92:95], v[84:87], v[144:159]
    v_cndmask_b32 v24, 0, v24, vcc
    v_cvt_pk_bf16_f32 v96, v24, v24
    v_and_b32 v103, 0xffff0000, v96
    v_sub_f32 v103, v24, v103
    v_cvt_pk_bf16_f32 v97, v103, v86
    s_nop 1
    v_mfma_f32_32x32x16_bf16 v[160:175], v[84:87], v[96:99], v[160:175]
    v_cndmask_b32 v22, 0, v22, vcc
    v_cvt_pk_bf16_f32 v88, v22, v22
    v_and_b32 v103, 0xffff0000, v88
    v_sub_f32 v103, v22, v103
    v_cvt_pk_bf16_f32 v89, v103, v86
    s_nop 1
    v_mfma_f32_32x32x16_bf16 v[128:143], v[88:91], v[84:87], v[128:143]
    v_mul_f32 v106, 0x3eb8aa3b, v104
    s_mov_b32 s44, 0x10000
    s_mov_b32 s45, 0x40000
    s_mov_b32 s46, 0x50000
    s_mov_b32 s47, 0x80000
    v_pk_mul_f32 v[144:145], v[144:145], v[104:105] op_sel_hi:[1,0]
    v_pk_mul_f32 v[146:147], v[146:147], v[104:105] op_sel_hi:[1,0]
    v_pk_mul_f32 v[148:149], v[148:149], v[104:105] op_sel_hi:[1,0]
    v_pk_mul_f32 v[150:151], v[150:151], v[104:105] op_sel_hi:[1,0]
    v_pk_mul_f32 v[152:153], v[152:153], v[104:105] op_sel_hi:[1,0]
    v_pk_mul_f32 v[154:155], v[154:155], v[104:105] op_sel_hi:[1,0]
    v_pk_mul_f32 v[156:157], v[156:157], v[104:105] op_sel_hi:[1,0]
    v_pk_mul_f32 v[158:159], v[158:159], v[104:105] op_sel_hi:[1,0]
    v_cvt_pk_bf16_f32 v28, v144, v145
    v_cvt_pk_bf16_f32 v29, v146, v147
    v_cvt_pk_bf16_f32 v30, v148, v149
    v_cvt_pk_bf16_f32 v31, v150, v151
    v_cvt_pk_bf16_f32 v32, v152, v153
    v_cvt_pk_bf16_f32 v33, v154, v155
    v_cvt_pk_bf16_f32 v34, v156, v157
    v_cvt_pk_bf16_f32 v35, v158, v159
    buffer_store_dwordx4 v[28:31], v123, s[16:19], s45 offen sc0 sc1
    buffer_store_dwordx4 v[32:35], v123, s[16:19], s46 offen sc0 sc1
    s_waitcnt lgkmcnt(0)
    v_pk_mul_f32 v[160:161], v[160:161], v[68:69]
    v_pk_mul_f32 v[162:163], v[162:163], v[70:71]
    v_pk_mul_f32 v[164:165], v[164:165], v[72:73]
    v_pk_mul_f32 v[166:167], v[166:167], v[74:75]
    v_pk_mul_f32 v[168:169], v[168:169], v[76:77]
    v_pk_mul_f32 v[170:171], v[170:171], v[78:79]
    v_pk_mul_f32 v[172:173], v[172:173], v[80:81]
    v_pk_mul_f32 v[174:175], v[174:175], v[82:83]
    v_cvt_pk_bf16_f32 v36, v160, v161
    v_cvt_pk_bf16_f32 v37, v162, v163
    v_cvt_pk_bf16_f32 v38, v164, v165
    v_cvt_pk_bf16_f32 v39, v166, v167
    v_cvt_pk_bf16_f32 v40, v168, v169
    v_cvt_pk_bf16_f32 v41, v170, v171
    v_cvt_pk_bf16_f32 v42, v172, v173
    v_cvt_pk_bf16_f32 v43, v174, v175
    buffer_store_dwordx4 v[36:39], v124, s[16:19], s47 offen sc0 sc1
    buffer_store_dwordx4 v[40:43], v124, s[16:19], s47 offen offset:512 sc0 sc1
    v_pk_mul_f32 v[128:129], v[128:129], v[106:107] op_sel_hi:[1,0]
    v_pk_mul_f32 v[130:131], v[130:131], v[106:107] op_sel_hi:[1,0]
    v_pk_mul_f32 v[132:133], v[132:133], v[106:107] op_sel_hi:[1,0]
    v_pk_mul_f32 v[134:135], v[134:135], v[106:107] op_sel_hi:[1,0]
    v_pk_mul_f32 v[136:137], v[136:137], v[106:107] op_sel_hi:[1,0]
    v_pk_mul_f32 v[138:139], v[138:139], v[106:107] op_sel_hi:[1,0]
    v_pk_mul_f32 v[140:141], v[140:141], v[106:107] op_sel_hi:[1,0]
    v_pk_mul_f32 v[142:143], v[142:143], v[106:107] op_sel_hi:[1,0]
    v_cvt_pk_bf16_f32 v20, v128, v129
    v_cvt_pk_bf16_f32 v21, v130, v131
    v_cvt_pk_bf16_f32 v22, v132, v133
    v_cvt_pk_bf16_f32 v23, v134, v135
    v_cvt_pk_bf16_f32 v24, v136, v137
    v_cvt_pk_bf16_f32 v25, v138, v139
    v_cvt_pk_bf16_f32 v26, v140, v141
    v_cvt_pk_bf16_f32 v27, v142, v143
    s_cmp_eq_u32 s3, 0
    s_cbranch_scc1 L_stg_3
    buffer_store_dwordx4 v[20:23], v122, s[16:19], 0 offen
    buffer_store_dwordx4 v[24:27], v122, s[16:19], s44 offen
    s_branch L_stj_4
L_stg_3:
    buffer_store_dwordx4 v[20:23], v122, s[16:19], 0 offen sc0 sc1
    buffer_store_dwordx4 v[24:27], v122, s[16:19], s44 offen sc0 sc1
L_stj_4:
    v_and_b32 v5, 27, v1
    v_cmp_eq_u32 vcc, 16, v5
    v_mov_b32 v6, 0x3f803f80
    s_nop 0
    v_cndmask_b32 v44, 0, v6, vcc
    v_mov_b32 v45, v44
    v_mov_b32 v46, v44
    v_mov_b32 v47, v44
    v_mov_b32 v48, v44
    v_mov_b32 v49, v44
    v_mov_b32 v50, v44
    v_mov_b32 v51, v44
    v_mov_b32 v52, v44
    v_mov_b32 v53, v44
    v_mov_b32 v54, v44
    v_mov_b32 v55, v44
    v_mov_b32 v56, v44
    v_mov_b32 v57, v44
    v_mov_b32 v58, v44
    v_mov_b32 v59, v44
    v_mov_b32 v60, v44
    v_mov_b32 v61, v44
    v_mov_b32 v62, v44
    v_mov_b32 v63, v44
    v_mov_b32 v64, v44
    v_mov_b32 v65, v44
    v_mov_b32 v66, v44
    v_mov_b32 v67, v44
    v_pk_mul_f32 v[176:177], 0, 0
    v_pk_mul_f32 v[178:179], 0, 0
    v_pk_mul_f32 v[180:181], 0, 0
    v_pk_mul_f32 v[182:183], 0, 0
    v_pk_mul_f32 v[184:185], 0, 0
    v_pk_mul_f32 v[186:187], 0, 0
    v_pk_mul_f32 v[188:189], 0, 0
    v_pk_mul_f32 v[190:191], 0, 0
    v_pk_mul_f32 v[192:193], 0, 0
    v_pk_mul_f32 v[194:195], 0, 0
    v_pk_mul_f32 v[196:197], 0, 0
    v_pk_mul_f32 v[198:199], 0, 0
    v_pk_mul_f32 v[200:201], 0, 0
    v_pk_mul_f32 v[202:203], 0, 0
    v_pk_mul_f32 v[204:205], 0, 0
    v_pk_mul_f32 v[206:207], 0, 0
    v_pk_mul_f32 v[208:209], 0, 0
    v_pk_mul_f32 v[210:211], 0, 0
    v_pk_mul_f32 v[212:213], 0, 0
    v_pk_mul_f32 v[214:215], 0, 0
    v_pk_mul_f32 v[216:217], 0, 0
    v_pk_mul_f32 v[218:219], 0, 0
    v_pk_mul_f32 v[220:221], 0, 0
    v_pk_mul_f32 v[222:223], 0, 0
    v_pk_mul_f32 v[224:225], 0, 0
    v_pk_mul_f32 v[226:227], 0, 0
    v_pk_mul_f32 v[228:229], 0, 0
    v_pk_mul_f32 v[230:231], 0, 0
    v_pk_mul_f32 v[232:233], 0, 0
    v_pk_mul_f32 v[234:235], 0, 0
    v_pk_mul_f32 v[236:237], 0, 0
    v_pk_mul_f32 v[238:239], 0, 0
    s_mul_i32 s47, s40, 0xc0000
    s_lshl_b32 s44, s65, 5
    s_add_u32 s44, s44, s64
    s_lshl_b32 s44, s44, 10
    s_add_u32 s86, s44, 0x600000
    s_mul_i32 s44, s42, 86
    s_mul_i32 s45, s41, 3
    s_add_u32 s44, s44, s45
    s_lshl_b32 s44, s44, 10
    s_add_u32 s79, s44, s47
    s_lshl_b32 s46, s70, 1
    s_add_u32 s46, s46, s72
    s_and_b32 s44, s46, 7
    s_mul_i32 s44, s44, 86
    s_add_u32 s44, s44, s73
    s_lshl_b32 s44, s44, 10
    s_add_u32 s85, s44, s47
    s_cmp_lt_u32 s73, 2
    s_cselect_b32 s87, 0, 0x40000000
    s_lshl_b32 s47, s46, 5
    s_lshl_b32 s45, s73, 3
    s_add_u32 s44, s47, s45
    s_lshl_b32 s44, s44, 10
    s_add_u32 s82, s44, 0x600000
    s_and_b32 s44, s73, 1
    s_lshl_b32 s44, s44, 1
    s_lshr_b32 s45, s73, 1
    s_add_u32 s88, s44, s45
    s_lshl_b32 s45, s71, 2
    s_add_u32 s44, s88, s45
    s_add_u32 s44, s44, s47
    s_lshl_b32 s80, s46, 15
    s_lshl_b32 s44, s88, 13
    s_add_u32 s80, s80, s44
    s_lshl_b32 s44, s71, 7
    s_add_u32 s80, s80, s44
    s_lshl_b32 s44, s46, 3
    s_add_u32 s44, s44, s71
    s_lshl_b32 s44, s44, 8
    s_add_u32 s81, s44, 0xa00000
    v_and_b32 v5, 31, v1
    v_lshrrev_b32 v6, 5, v1
    s_lshl_b32 s44, s46, 15
    s_lshl_b32 s45, s71, 7
    s_add_u32 s44, s44, s45
    s_lshl_b32 s47, s88, 5
    s_add_u32 s44, s44, s47
    v_lshlrev_b32 v7, 10, v5
    v_lshl_add_u32 v7, v6, 4, v7
    v_add_u32 v249, s44, v7
    v_lshlrev_b32 v7, 3, v5
    v_lshl_add_u32 v248, v6, 2, v7
    v_lshl_add_u32 v250, v6, 10, v7
    v_lshl_add_u32 v251, v1, 2, s69
    s_lshl_b32 s44, s70, 16
    s_add_u32 s44, s44, s69
    s_add_u32 s77, s44, s45
    v_bfe_u32 v7, v1, 1, 3
    s_lshl_b32 s44, s88, 1
    v_xor_b32 v7, s44, v7
    v_lshlrev_b32 v7, 4, v7
    v_lshl_add_u32 v7, v6, 3, v7
    v_and_b32 v5, 7, v1
    v_lshl_add_u32 v7, v5, 7, v7
    v_bfe_u32 v247, v1, 3, 2
    v_lshl_add_u32 v7, v247, 13, v7
    s_lshl_b32 s44, s72, 15
    s_add_u32 s44, s44, 6912
    v_add_u32 v247, s44, v7
    v_lshrrev_b32 v7, 4, v1
    s_lshl_b32 s44, s72, 2
    v_xor_b32 v7, s44, v7
    v_xor_b32 v7, v5, v7
    v_lshlrev_b32 v7, 4, v7
    v_lshrrev_b32 v246, 3, v1
    v_lshl_add_u32 v246, v246, 10, v7
    v_lshrrev_b32 v7, 3, v1
    v_lshlrev_b32 v7, 10, v7
    v_lshl_add_u32 v175, v5, 4, v7
    v_bfe_u32 v7, v1, 4, 1
    v_lshlrev_b32 v11, 2, v7
    v_xor_b32 v11, v5, v11
    v_lshlrev_b32 v11, 4, v11
    v_lshrrev_b32 v5, 3, v1
    v_lshl_add_u32 v11, v5, 10, v11
    v_add_u32 v11, s45, v11
    v_bfe_u32 v5, v1, 2, 2
    v_xor_b32 v242, v6, v7
    v_lshl_add_u32 v242, v242, 2, v5
    v_lshlrev_b32 v242, 5, v242
    v_lshl_add_u32 v242, v7, 10, v242
    v_and_b32 v243, 3, v1
    v_lshl_add_u32 v242, v243, 3, v242
    v_lshl_add_u32 v5, v6, 2, v5
    v_lshlrev_b32 v5, 7, v5
    v_lshl_add_u32 v5, v243, 3, v5
    v_lshl_add_u32 v5, v7, 5, v5
    v_bfe_u32 v7, v1, 3, 1
    s_and_b32 s44, s73, 1
    v_xor_b32 v7, s44, v7
    v_lshl_add_u32 v8, v7, 6, v5
    v_xor_b32 v9, 64, v8
    v_add_u32 v243, 114688, v242
    v_add_u32 v242, 0x10000, v242
    s_lshl_b32 s44, s73, 14
    v_add_u32 v244, s44, v8
    v_add_u32 v245, s44, v9
    s_waitcnt vmcnt(0)
    s_barrier
L_p1_join:
    v_add_u32 v5, s69, v8
    v_add_u32 v6, s69, v9
    s_cmp_eq_u32 s3, 0
    s_cselect_b32 s44, 0x1200000, 0
    s_add_u32 s79, s79, s44
    s_add_u32 s85, s85, s44
    s_cmp_lg_u32 s42, 7
    s_cbranch_scc1 L_pollskip_5
    s_add_u32 s44, s37, 0
    s_mov_b64 exec, 0xffffffff
    s_mov_b32 s45, 200000
L_poll_6:
    buffer_load_dword v4, v3, s[16:19], s44 offen sc0 sc1
    s_sub_u32 s45, s45, 1
    s_cbranch_scc1 L_poll_6_out
    s_waitcnt vmcnt(0)
    v_cmp_ne_u32 vcc, s43, v4
    s_cbranch_vccnz L_poll_6
L_poll_6_out:
    s_waitcnt vmcnt(0)
    s_mov_b64 exec, -1
L_pollskip_5:
    s_barrier
    s_xor_b32 s44, s65, 1
    s_lshl_b32 s44, s44, 10
    s_add_u32 s44, s44, s67
    buffer_load_dwordx4 v[20:23], v2, s[16:19], s44 offen sc0 sc1
    s_add_u32 s49, s66, 0x40000
    s_add_u32 s48, s66, 0x80000
    buffer_load_dwordx4 v[32:35], v2, s[16:19], s49 offen offset:0 sc0 sc1
    s_mov_b64 exec, s[90:91]
    buffer_load_dwordx4 v[44:47], v240, s[16:19], s48 offen offset:0 sc0 sc1
    buffer_load_dwordx4 v[48:51], v240, s[16:19], s48 offen offset:512 sc0 sc1
    s_mov_b64 exec, -1
    s_xor_b32 s44, s65, 2
    s_lshl_b32 s44, s44, 10
    s_add_u32 s44, s44, s67
    buffer_load_dwordx4 v[24:27], v2, s[16:19], s44 offen sc0 sc1
    s_xor_b32 s44, s65, 3
    s_lshl_b32 s44, s44, 10
    s_add_u32 s44, s44, s67
    buffer_load_dwordx4 v[28:31], v2, s[16:19], s44 offen sc0 sc1
    s_xor_b32 s44, s65, 0
    s_lshl_b32 s44, s44, 10
    s_add_u32 s44, s44, s67
    buffer_load_dwordx4 v[16:19], v2, s[16:19], s44 offen sc0 sc1
    buffer_load_dwordx4 v[36:39], v2, s[16:19], s49 offen offset:1024 sc0 sc1
    s_mov_b64 exec, s[90:91]
    buffer_load_dwordx4 v[52:55], v240, s[16:19], s48 offen offset:1024 sc0 sc1
    buffer_load_dwordx4 v[56:59], v240, s[16:19], s48 offen offset:1536 sc0 sc1
    s_mov_b64 exec, -1
    s_waitcnt vmcnt(8)
    v_mfma_f32_32x32x16_bf16 v[68:83], v[32:35], v[20:23], 0
    s_waitcnt vmcnt(5)
    s_nop 7
    s_nop 2
    s_setprio 3
    v_exp_f32 v68, v68
    v_exp_f32 v69, v69
    buffer_load_dwordx4 v[40:43], v2, s[16:19], s49 offen offset:2048 sc0 sc1
    s_mov_b64 exec, s[90:91]
    buffer_load_dwordx4 v[60:63], v240, s[16:19], s48 offen offset:2048 sc0 sc1
    buffer_load_dwordx4 v[64:67], v240, s[16:19], s48 offen offset:2560 sc0 sc1
    s_mov_b64 exec, -1
    v_exp_f32 v70, v70
    v_exp_f32 v71, v71
    v_exp_f32 v72, v72
    s_waitcnt vmcnt(8)
    v_mfma_f32_32x32x16_bf16 v[84:99], v[32:35], v[24:27], 0
    v_exp_f32 v73, v73
    v_exp_f32 v74, v74
    v_exp_f32 v75, v75
    v_exp_f32 v76, v76
    v_exp_f32 v77, v77
    v_exp_f32 v78, v78
    v_smfmac_f32_32x32x32_bf16 v[192:207], v[44:47], v[68:75], v241
    v_exp_f32 v79, v79
    v_exp_f32 v80, v80
    v_exp_f32 v81, v81
    v_exp_f32 v82, v82
    v_exp_f32 v83, v83
    v_exp_f32 v84, v84
    v_exp_f32 v85, v85
    v_smfmac_f32_32x32x32_bf16 v[192:207], v[48:51], v[76:83], v241
    v_exp_f32 v86, v86
    v_exp_f32 v87, v87
    v_exp_f32 v88, v88
    s_waitcnt vmcnt(7)
    v_mfma_f32_32x32x16_bf16 v[68:83], v[32:35], v[28:31], 0
    s_cmp_lg_u32 s73, 0
    s_cbranch_scc1 L_w4_7
    s_add_u32 s46, s40, 0
    s_and_b32 s46, s46, 3
    s_mul_i32 s44, s46, 352256
    s_mul_i32 s46, s46, 24576
    s_add_u32 m0, s46, s74
    s_add_u32 s44, s44, s75
    buffer_load_dwordx4 v10, s[24:27], s44 offen  lds
    s_add_u32 m0, m0, 2048
    s_add_u32 s44, s44, 32
    buffer_load_dwordx4 v10, s[24:27], s44 offen  lds
    s_add_u32 m0, m0, 2048
    s_add_u32 s44, s44, 32
    buffer_load_dwordx4 v10, s[24:27], s44 offen  lds
L_w4_7:
    v_exp_f32 v89, v89
    v_exp_f32 v90, v90
    v_exp_f32 v91, v91
    v_exp_f32 v92, v92
    v_exp_f32 v93, v93
    v_exp_f32 v94, v94
    v_smfmac_f32_32x32x32_bf16 v[208:223], v[44:47], v[84:91], v241
    v_exp_f32 v95, v95
    v_exp_f32 v96, v96
    v_exp_f32 v97, v97
    v_exp_f32 v98, v98
    v_exp_f32 v99, v99
    v_exp_f32 v68, v68
    v_exp_f32 v69, v69
    v_smfmac_f32_32x32x32_bf16 v[208:223], v[48:51], v[92:99], v241
    v_exp_f32 v70, v70
    v_exp_f32 v71, v71
    v_exp_f32 v72, v72
    s_waitcnt vmcnt(6)
    v_mfma_f32_32x32x16_bf16 v[84:99], v[32:35], v[16:19], 0
    s_add_u32 s45, s40, 0
    s_and_b32 s45, s45, 3
    s_lshl_b32 s45, s45, 11
    s_add_u32 m0, s69, s45
    s_lshl_b32 s45, s45, 3
    s_add_u32 s44, s76, s45
    buffer_load_dwordx4 v11, s[20:23], s44 offen  lds
    s_add_u32 m0, m0, 1024
    s_add_u32 s44, s44, 8192
    buffer_load_dwordx4 v11, s[20:23], s44 offen  lds
    v_exp_f32 v73, v73
    v_exp_f32 v74, v74
    v_exp_f32 v75, v75
    v_exp_f32 v76, v76
    v_exp_f32 v77, v77
    v_exp_f32 v78, v78
    v_smfmac_f32_32x32x32_bf16 v[224:239], v[44:47], v[68:75], v241
    v_exp_f32 v79, v79
    v_exp_f32 v80, v80
    v_exp_f32 v81, v81
    v_exp_f32 v82, v82
    v_exp_f32 v83, v83
    v_exp_f32 v84, v84
    v_exp_f32 v85, v85
    v_smfmac_f32_32x32x32_bf16 v[224:239], v[48:51], v[76:83], v241
    v_exp_f32 v86, v86
    v_exp_f32 v87, v87
    v_exp_f32 v88, v88
    s_waitcnt vmcnt(5)
    v_mfma_f32_32x32x16_bf16 v[68:83], v[36:39], v[20:23], 0
    v_exp_f32 v89, v89
    v_exp_f32 v90, v90
    v_exp_f32 v91, v91
    v_exp_f32 v92, v92
    v_exp_f32 v93, v93
    v_exp_f32 v94, v94
    v_smfmac_f32_32x32x32_bf16 v[176:191], v[44:47], v[84:91], v241
    v_exp_f32 v95, v95
    v_exp_f32 v96, v96
    v_exp_f32 v97, v97
    v_exp_f32 v98, v98
    v_exp_f32 v99, v99
    v_exp_f32 v68, v68
    v_exp_f32 v69, v69
    v_smfmac_f32_32x32x32_bf16 v[176:191], v[48:51], v[92:99], v241
    buffer_load_dwordx4 v[32:35], v2, s[16:19], s49 offen offset:3072 sc0 sc1
    s_mov_b64 exec, s[90:91]
    buffer_load_dwordx4 v[44:47], v240, s[16:19], s48 offen offset:3072 sc0 sc1
    buffer_load_dwordx4 v[48:51], v240, s[16:19], s48 offen offset:3584 sc0 sc1
    s_mov_b64 exec, -1
    v_exp_f32 v70, v70
    v_exp_f32 v71, v71
    v_exp_f32 v72, v72
    v_mfma_f32_32x32x16_bf16 v[84:99], v[36:39], v[24:27], 0
    s_cmp_lg_u32 s73, 1
    s_cbranch_scc1 L_w4_8
    s_add_u32 s46, s40, 0
    s_and_b32 s46, s46, 3
    s_mul_i32 s44, s46, 352256
    s_mul_i32 s46, s46, 24576
    s_add_u32 m0, s46, s74
    s_add_u32 s44, s44, s75
    buffer_load_dwordx4 v10, s[24:27], s44 offen  lds
    s_add_u32 m0, m0, 2048
    s_add_u32 s44, s44, 32
    buffer_load_dwordx4 v10, s[24:27], s44 offen  lds
    s_add_u32 m0, m0, 2048
    s_add_u32 s44, s44, 32
    buffer_load_dwordx4 v10, s[24:27], s44 offen  lds
L_w4_8:
    v_exp_f32 v73, v73
    v_exp_f32 v74, v74
    v_exp_f32 v75, v75
    v_exp_f32 v76, v76
    v_exp_f32 v77, v77
    v_exp_f32 v78, v78
    v_smfmac_f32_32x32x32_bf16 v[192:207], v[52:55], v[68:75], v241
    v_exp_f32 v79, v79
    v_exp_f32 v80, v80
    v_exp_f32 v81, v81
    v_exp_f32 v82, v82
    v_exp_f32 v83, v83
    v_exp_f32 v84, v84
    v_exp_f32 v85, v85
    v_smfmac_f32_32x32x32_bf16 v[192:207], v[56:59], v[76:83], v241
    v_exp_f32 v86, v86
    v_exp_f32 v87, v87
    v_exp_f32 v88, v88
    v_mfma_f32_32x32x16_bf16 v[68:83], v[36:39], v[28:31], 0
    v_exp_f32 v89, v89
    v_exp_f32 v90, v90
    v_exp_f32 v91, v91
    v_exp_f32 v92, v92
    v_exp_f32 v93, v93
    v_exp_f32 v94, v94
    v_smfmac_f32_32x32x32_bf16 v[208:223], v[52:55], v[84:91], v241
    v_exp_f32 v95, v95
    v_exp_f32 v96, v96
    v_exp_f32 v97, v97
    v_exp_f32 v98, v98
    v_exp_f32 v99, v99
    v_exp_f32 v68, v68
    v_exp_f32 v69, v69
    v_smfmac_f32_32x32x32_bf16 v[208:223], v[56:59], v[92:99], v241
    v_exp_f32 v70, v70
    v_exp_f32 v71, v71
    v_exp_f32 v72, v72
    v_mfma_f32_32x32x16_bf16 v[84:99], v[36:39], v[16:19], 0
    s_add_u32 s45, s40, 1
    s_and_b32 s45, s45, 3
    s_lshl_b32 s45, s45, 11
    s_add_u32 m0, s69, s45
    s_lshl_b32 s45, s45, 3
    s_add_u32 s44, s76, s45
    buffer_load_dwordx4 v11, s[20:23], s44 offen  lds
    s_add_u32 m0, m0, 1024
    s_add_u32 s44, s44, 8192
    buffer_load_dwordx4 v11, s[20:23], s44 offen  lds
    v_exp_f32 v73, v73
    v_exp_f32 v74, v74
    v_exp_f32 v75, v75
    v_exp_f32 v76, v76
    v_exp_f32 v77, v77
    v_exp_f32 v78, v78
    v_smfmac_f32_32x32x32_bf16 v[224:239], v[52:55], v[68:75], v241
    v_exp_f32 v79, v79
    v_exp_f32 v80, v80
    v_exp_f32 v81, v81
    v_exp_f32 v82, v82
    v_exp_f32 v83, v83
    v_exp_f32 v84, v84
    v_exp_f32 v85, v85
    v_smfmac_f32_32x32x32_bf16 v[224:239], v[56:59], v[76:83], v241
    v_exp_f32 v86, v86
    v_exp_f32 v87, v87
    v_exp_f32 v88, v88
    s_waitcnt vmcnt(7)
    v_mfma_f32_32x32x16_bf16 v[68:83], v[40:43], v[20:23], 0
    v_exp_f32 v89, v89
    v_exp_f32 v90, v90
    v_exp_f32 v91, v91
    v_exp_f32 v92, v92
    v_exp_f32 v93, v93
    v_exp_f32 v94, v94
    v_smfmac_f32_32x32x32_bf16 v[176:191], v[52:55], v[84:91], v241
    v_exp_f32 v95, v95
    v_exp_f32 v96, v96
    v_exp_f32 v97, v97
    v_exp_f32 v98, v98
    v_exp_f32 v99, v99
    v_exp_f32 v68, v68
    v_exp_f32 v69, v69
    v_smfmac_f32_32x32x32_bf16 v[176:191], v[56:59], v[92:99], v241
    s_add_u32 s49, s66, 0x41000
    s_add_u32 s48, s66, 0x81000
    buffer_load_dwordx4 v[36:39], v2, s[16:19], s49 offen offset:0 sc0 sc1
    s_mov_b64 exec, s[90:91]
    buffer_load_dwordx4 v[52:55], v240, s[16:19], s48 offen offset:0 sc0 sc1
    buffer_load_dwordx4 v[56:59], v240, s[16:19], s48 offen offset:512 sc0 sc1
    s_mov_b64 exec, -1
    v_exp_f32 v70, v70
    v_exp_f32 v71, v71
    v_exp_f32 v72, v72
    v_mfma_f32_32x32x16_bf16 v[84:99], v[40:43], v[24:27], 0
    s_cmp_lg_u32 s73, 2
    s_cbranch_scc1 L_w4_9
    s_add_u32 s46, s40, 0
    s_and_b32 s46, s46, 3
    s_mul_i32 s44, s46, 352256
    s_mul_i32 s46, s46, 24576
    s_add_u32 m0, s46, s74
    s_add_u32 s44, s44, s75
    buffer_load_dwordx4 v10, s[24:27], s44 offen  lds
    s_add_u32 m0, m0, 2048
    s_add_u32 s44, s44, 32
    buffer_load_dwordx4 v10, s[24:27], s44 offen  lds
    s_add_u32 m0, m0, 2048
    s_add_u32 s44, s44, 32
    buffer_load_dwordx4 v10, s[24:27], s44 offen  lds
L_w4_9:
    v_exp_f32 v73, v73
    v_exp_f32 v74, v74
    v_exp_f32 v75, v75
    v_exp_f32 v76, v76
    v_exp_f32 v77, v77
    v_exp_f32 v78, v78
    v_smfmac_f32_32x32x32_bf16 v[192:207], v[60:63], v[68:75], v241
    v_exp_f32 v79, v79
    v_exp_f32 v80, v80
    v_exp_f32 v81, v81
    v_exp_f32 v82, v82
    v_exp_f32 v83, v83
    v_exp_f32 v84, v84
    v_exp_f32 v85, v85
    v_smfmac_f32_32x32x32_bf16 v[192:207], v[64:67], v[76:83], v241
    v_exp_f32 v86, v86
    v_exp_f32 v87, v87
    v_exp_f32 v88, v88
    v_mfma_f32_32x32x16_bf16 v[68:83], v[40:43], v[28:31], 0
    v_exp_f32 v89, v89
    v_exp_f32 v90, v90
    v_exp_f32 v91, v91
    v_exp_f32 v92, v92
    v_exp_f32 v93, v93
    v_exp_f32 v94, v94
    v_smfmac_f32_32x32x32_bf16 v[208:223], v[60:63], v[84:91], v241
    v_exp_f32 v95, v95
    v_exp_f32 v96, v96
    v_exp_f32 v97, v97
    v_exp_f32 v98, v98
    v_exp_f32 v99, v99
    v_exp_f32 v68, v68
    v_exp_f32 v69, v69
    v_smfmac_f32_32x32x32_bf16 v[208:223], v[64:67], v[92:99], v241
    v_exp_f32 v70, v70
    v_exp_f32 v71, v71
    v_exp_f32 v72, v72
    v_mfma_f32_32x32x16_bf16 v[84:99], v[40:43], v[16:19], 0
    s_add_u32 s45, s40, 2
    s_and_b32 s45, s45, 3
    s_lshl_b32 s45, s45, 11
    s_add_u32 m0, s69, s45
    s_lshl_b32 s45, s45, 3
    s_add_u32 s44, s76, s45
    buffer_load_dwordx4 v11, s[20:23], s44 offen  lds
    s_add_u32 m0, m0, 1024
    s_add_u32 s44, s44, 8192
    buffer_load_dwordx4 v11, s[20:23], s44 offen  lds
    v_exp_f32 v73, v73
    v_exp_f32 v74, v74
    v_exp_f32 v75, v75
    v_exp_f32 v76, v76
    v_exp_f32 v77, v77
    v_exp_f32 v78, v78
    v_smfmac_f32_32x32x32_bf16 v[224:239], v[60:63], v[68:75], v241
    v_exp_f32 v79, v79
    v_exp_f32 v80, v80
    v_exp_f32 v81, v81
    v_exp_f32 v82, v82
    v_exp_f32 v83, v83
    v_exp_f32 v84, v84
    v_exp_f32 v85, v85
    v_smfmac_f32_32x32x32_bf16 v[224:239], v[64:67], v[76:83], v241
    v_exp_f32 v86, v86
    v_exp_f32 v87, v87
    v_exp_f32 v88, v88
    s_waitcnt vmcnt(7)
    v_mfma_f32_32x32x16_bf16 v[68:83], v[32:35], v[20:23], 0
    s_cmp_lg_u32 s73, 3
    s_cbranch_scc1 L_w4_10
    s_add_u32 s46, s40, 0
    s_and_b32 s46, s46, 3
    s_mul_i32 s44, s46, 352256
    s_mul_i32 s46, s46, 24576
    s_add_u32 m0, s46, s74
    s_add_u32 s44, s44, s75
    buffer_load_dwordx4 v10, s[24:27], s44 offen  lds
    s_add_u32 m0, m0, 2048
    s_add_u32 s44, s44, 32
    buffer_load_dwordx4 v10, s[24:27], s44 offen  lds
    s_add_u32 m0, m0, 2048
    s_add_u32 s44, s44, 32
    buffer_load_dwordx4 v10, s[24:27], s44 offen  lds
L_w4_10:
    v_exp_f32 v89, v89
    v_exp_f32 v90, v90
    v_exp_f32 v91, v91
    v_exp_f32 v92, v92
    v_exp_f32 v93, v93
    v_exp_f32 v94, v94
    v_smfmac_f32_32x32x32_bf16 v[176:191], v[60:63], v[84:91], v241
    v_exp_f32 v95, v95
    v_exp_f32 v96, v96
    v_exp_f32 v97, v97
    v_exp_f32 v98, v98
    v_exp_f32 v99, v99
    v_exp_f32 v68, v68
    v_exp_f32 v69, v69
    v_smfmac_f32_32x32x32_bf16 v[176:191], v[64:67], v[92:99], v241
    buffer_load_dwordx4 v[40:43], v2, s[16:19], s49 offen offset:1024 sc0 sc1
    s_mov_b64 exec, s[90:91]
    buffer_load_dwordx4 v[60:63], v240, s[16:19], s48 offen offset:1024 sc0 sc1
    buffer_load_dwordx4 v[64:67], v240, s[16:19], s48 offen offset:1536 sc0 sc1
    s_mov_b64 exec, -1
    v_exp_f32 v70, v70
    v_exp_f32 v71, v71
    v_exp_f32 v72, v72
    v_mfma_f32_32x32x16_bf16 v[84:99], v[32:35], v[24:27], 0
    v_exp_f32 v73, v73
    v_exp_f32 v74, v74
    v_exp_f32 v75, v75
    v_exp_f32 v76, v76
    v_exp_f32 v77, v77
    v_exp_f32 v78, v78
    v_smfmac_f32_32x32x32_bf16 v[192:207], v[44:47], v[68:75], v241
    v_exp_f32 v79, v79
    v_exp_f32 v80, v80
    v_exp_f32 v81, v81
    v_exp_f32 v82, v82
    v_exp_f32 v83, v83
    v_exp_f32 v84, v84
    v_exp_f32 v85, v85
    v_smfmac_f32_32x32x32_bf16 v[192:207], v[48:51], v[76:83], v241
    v_exp_f32 v86, v86
    v_exp_f32 v87, v87
    v_exp_f32 v88, v88
    v_mfma_f32_32x32x16_bf16 v[68:83], v[32:35], v[28:31], 0
    v_exp_f32 v89, v89
    v_exp_f32 v90, v90
    v_exp_f32 v91, v91
    v_exp_f32 v92, v92
    v_exp_f32 v93, v93
    v_exp_f32 v94, v94
    v_smfmac_f32_32x32x32_bf16 v[208:223], v[44:47], v[84:91], v241
    v_exp_f32 v95, v95
    v_exp_f32 v96, v96
    v_exp_f32 v97, v97
    v_exp_f32 v98, v98
    v_exp_f32 v99, v99
    v_exp_f32 v68, v68
    v_exp_f32 v69, v69
    v_smfmac_f32_32x32x32_bf16 v[208:223], v[48:51], v[92:99], v241
    v_exp_f32 v70, v70
    v_exp_f32 v71, v71
    v_exp_f32 v72, v72
    v_mfma_f32_32x32x16_bf16 v[84:99], v[32:35], v[16:19], 0
    s_add_u32 s45, s40, 3
    s_and_b32 s45, s45, 3
    s_lshl_b32 s45, s45, 11
    s_add_u32 m0, s69, s45
    s_lshl_b32 s45, s45, 3
    s_add_u32 s44, s76, s45
    buffer_load_dwordx4 v11, s[20:23], s44 offen  lds
    s_add_u32 m0, m0, 1024
    s_add_u32 s44, s44, 8192
    buffer_load_dwordx4 v11, s[20:23], s44 offen  lds
    v_exp_f32 v73, v73
    v_exp_f32 v74, v74
    v_exp_f32 v75, v75
    v_exp_f32 v76, v76
    v_exp_f32 v77, v77
    v_exp_f32 v78, v78
    v_smfmac_f32_32x32x32_bf16 v[224:239], v[44:47], v[68:75], v241
    v_exp_f32 v79, v79
    v_exp_f32 v80, v80
    v_exp_f32 v81, v81
    v_exp_f32 v82, v82
    v_exp_f32 v83, v83
    v_exp_f32 v84, v84
    v_exp_f32 v85, v85
    v_smfmac_f32_32x32x32_bf16 v[224:239], v[48:51], v[76:83], v241
    v_exp_f32 v86, v86
    v_exp_f32 v87, v87
    v_exp_f32 v88, v88
    s_waitcnt vmcnt(7)
    v_mfma_f32_32x32x16_bf16 v[68:83], v[36:39], v[20:23], 0
    s_cmp_lg_u32 s73, 0
    s_cbranch_scc1 L_w4_11
    s_add_u32 s46, s40, 1
    s_and_b32 s46, s46, 3
    s_mul_i32 s44, s46, 352256
    s_mul_i32 s46, s46, 24576
    s_add_u32 m0, s46, s74
    s_add_u32 s44, s44, s75
    buffer_load_dwordx4 v10, s[24:27], s44 offen  lds
    s_add_u32 m0, m0, 2048
    s_add_u32 s44, s44, 32
    buffer_load_dwordx4 v10, s[24:27], s44 offen  lds
    s_add_u32 m0, m0, 2048
    s_add_u32 s44, s44, 32
    buffer_load_dwordx4 v10, s[24:27], s44 offen  lds
L_w4_11:
    v_exp_f32 v89, v89
    v_exp_f32 v90, v90
    v_exp_f32 v91, v91
    v_exp_f32 v92, v92
    v_exp_f32 v93, v93
    v_exp_f32 v94, v94
    v_smfmac_f32_32x32x32_bf16 v[176:191], v[44:47], v[84:91], v241
    v_exp_f32 v95, v95
    v_exp_f32 v96, v96
    v_exp_f32 v97, v97
    v_exp_f32 v98, v98
    v_exp_f32 v99, v99
    v_exp_f32 v68, v68
    v_exp_f32 v69, v69
    v_smfmac_f32_32x32x32_bf16 v[176:191], v[48:51], v[92:99], v241
    buffer_load_dwordx4 v[32:35], v2, s[16:19], s49 offen offset:2048 sc0 sc1
    s_mov_b64 exec, s[90:91]
    buffer_load_dwordx4 v[44:47], v240, s[16:19], s48 offen offset:2048 sc0 sc1
    buffer_load_dwordx4 v[48:51], v240, s[16:19], s48 offen offset:2560 sc0 sc1
    s_mov_b64 exec, -1
    v_exp_f32 v70, v70
    v_exp_f32 v71, v71
    v_exp_f32 v72, v72
    v_mfma_f32_32x32x16_bf16 v[84:99], v[36:39], v[24:27], 0
    v_exp_f32 v73, v73
    v_exp_f32 v74, v74
    v_exp_f32 v75, v75
    v_exp_f32 v76, v76
    v_exp_f32 v77, v77
    v_exp_f32 v78, v78
    v_smfmac_f32_32x32x32_bf16 v[192:207], v[52:55], v[68:75], v241
    v_exp_f32 v79, v79
    v_exp_f32 v80, v80
    v_exp_f32 v81, v81
    v_exp_f32 v82, v82
    v_exp_f32 v83, v83
    v_exp_f32 v84, v84
    v_exp_f32 v85, v85
    v_smfmac_f32_32x32x32_bf16 v[192:207], v[56:59], v[76:83], v241
    v_exp_f32 v86, v86
    v_exp_f32 v87, v87
    v_exp_f32 v88, v88
    v_mfma_f32_32x32x16_bf16 v[68:83], v[36:39], v[28:31], 0
    v_exp_f32 v89, v89
    v_exp_f32 v90, v90
    v_exp_f32 v91, v91
    v_exp_f32 v92, v92
    v_exp_f32 v93, v93
    v_exp_f32 v94, v94
    v_smfmac_f32_32x32x32_bf16 v[208:223], v[52:55], v[84:91], v241
    v_exp_f32 v95, v95
    v_exp_f32 v96, v96
    v_exp_f32 v97, v97
    v_exp_f32 v98, v98
    v_exp_f32 v99, v99
    v_exp_f32 v68, v68
    v_exp_f32 v69, v69
    v_smfmac_f32_32x32x32_bf16 v[208:223], v[56:59], v[92:99], v241
    v_exp_f32 v70, v70
    v_exp_f32 v71, v71
    v_exp_f32 v72, v72
    v_mfma_f32_32x32x16_bf16 v[84:99], v[36:39], v[16:19], 0
    s_cmp_lg_u32 s73, 1
    s_cbranch_scc1 L_w4_12
    s_add_u32 s46, s40, 1
    s_and_b32 s46, s46, 3
    s_mul_i32 s44, s46, 352256
    s_mul_i32 s46, s46, 24576
    s_add_u32 m0, s46, s74
    s_add_u32 s44, s44, s75
    buffer_load_dwordx4 v10, s[24:27], s44 offen  lds
    s_add_u32 m0, m0, 2048
    s_add_u32 s44, s44, 32
    buffer_load_dwordx4 v10, s[24:27], s44 offen  lds
    s_add_u32 m0, m0, 2048
    s_add_u32 s44, s44, 32
    buffer_load_dwordx4 v10, s[24:27], s44 offen  lds
L_w4_12:
    v_exp_f32 v73, v73
    v_exp_f32 v74, v74
    v_exp_f32 v75, v75
    v_exp_f32 v76, v76
    v_exp_f32 v77, v77
    v_exp_f32 v78, v78
    v_smfmac_f32_32x32x32_bf16 v[224:239], v[52:55], v[68:75], v241
    v_exp_f32 v79, v79
    v_exp_f32 v80, v80
    v_exp_f32 v81, v81
    v_exp_f32 v82, v82
    v_exp_f32 v83, v83
    v_exp_f32 v84, v84
    v_exp_f32 v85, v85
    v_smfmac_f32_32x32x32_bf16 v[224:239], v[56:59], v[76:83], v241
    v_exp_f32 v86, v86
    v_exp_f32 v87, v87
    v_exp_f32 v88, v88
    s_waitcnt vmcnt(5)
    v_mfma_f32_32x32x16_bf16 v[68:83], v[40:43], v[20:23], 0
    v_exp_f32 v89, v89
    v_exp_f32 v90, v90
    v_exp_f32 v91, v91
    v_exp_f32 v92, v92
    v_exp_f32 v93, v93
    v_exp_f32 v94, v94
    v_smfmac_f32_32x32x32_bf16 v[176:191], v[52:55], v[84:91], v241
    v_exp_f32 v95, v95
    v_exp_f32 v96, v96
    v_exp_f32 v97, v97
    v_exp_f32 v98, v98
    v_exp_f32 v99, v99
    v_exp_f32 v68, v68
    v_exp_f32 v69, v69
    v_smfmac_f32_32x32x32_bf16 v[176:191], v[56:59], v[92:99], v241
    buffer_load_dwordx4 v[36:39], v2, s[16:19], s49 offen offset:3072 sc0 sc1
    s_mov_b64 exec, s[90:91]
    buffer_load_dwordx4 v[52:55], v240, s[16:19], s48 offen offset:3072 sc0 sc1
    buffer_load_dwordx4 v[56:59], v240, s[16:19], s48 offen offset:3584 sc0 sc1
    s_mov_b64 exec, -1
    v_exp_f32 v70, v70
    v_exp_f32 v71, v71
    v_exp_f32 v72, v72
    v_mfma_f32_32x32x16_bf16 v[84:99], v[40:43], v[24:27], 0
    v_exp_f32 v73, v73
    v_exp_f32 v74, v74
    v_exp_f32 v75, v75
    v_exp_f32 v76, v76
    v_exp_f32 v77, v77
    v_exp_f32 v78, v78
    v_smfmac_f32_32x32x32_bf16 v[192:207], v[60:63], v[68:75], v241
    v_exp_f32 v79, v79
    v_exp_f32 v80, v80
    v_exp_f32 v81, v81
    v_exp_f32 v82, v82
    v_exp_f32 v83, v83
    v_exp_f32 v84, v84
    v_exp_f32 v85, v85
    v_smfmac_f32_32x32x32_bf16 v[192:207], v[64:67], v[76:83], v241
    v_exp_f32 v86, v86
    v_exp_f32 v87, v87
    v_exp_f32 v88, v88
    v_mfma_f32_32x32x16_bf16 v[68:83], v[40:43], v[28:31], 0
    v_exp_f32 v89, v89
    v_exp_f32 v90, v90
    v_exp_f32 v91, v91
    v_exp_f32 v92, v92
    v_exp_f32 v93, v93
    v_exp_f32 v94, v94
    v_smfmac_f32_32x32x32_bf16 v[208:223], v[60:63], v[84:91], v241
    v_exp_f32 v95, v95
    v_exp_f32 v96, v96
    v_exp_f32 v97, v97
    v_exp_f32 v98, v98
    v_exp_f32 v99, v99
    v_exp_f32 v68, v68
    v_exp_f32 v69, v69
    v_smfmac_f32_32x32x32_bf16 v[208:223], v[64:67], v[92:99], v241
    v_exp_f32 v70, v70
    v_exp_f32 v71, v71
    v_exp_f32 v72, v72
    v_mfma_f32_32x32x16_bf16 v[84:99], v[40:43], v[16:19], 0
    s_cmp_lg_u32 s73, 2
    s_cbranch_scc1 L_w4_13
    s_add_u32 s46, s40, 1
    s_and_b32 s46, s46, 3
    s_mul_i32 s44, s46, 352256
    s_mul_i32 s46, s46, 24576
    s_add_u32 m0, s46, s74
    s_add_u32 s44, s44, s75
    buffer_load_dwordx4 v10, s[24:27], s44 offen  lds
    s_add_u32 m0, m0, 2048
    s_add_u32 s44, s44, 32
    buffer_load_dwordx4 v10, s[24:27], s44 offen  lds
    s_add_u32 m0, m0, 2048
    s_add_u32 s44, s44, 32
    buffer_load_dwordx4 v10, s[24:27], s44 offen  lds
L_w4_13:
    s_waitcnt vmcnt(6)
    ds_read_b64_tr_b16 v[100:101], v5 offset:0
    ds_read_b64_tr_b16 v[102:103], v5 offset:1024
    ds_read_b64_tr_b16 v[104:105], v6 offset:0
    ds_read_b64_tr_b16 v[106:107], v6 offset:1024
    ds_read_b64_tr_b16 v[108:109], v5 offset:2048
    ds_read_b64_tr_b16 v[110:111], v5 offset:3072
    ds_read_b64_tr_b16 v[112:113], v6 offset:2048
    ds_read_b64_tr_b16 v[114:115], v6 offset:3072
    v_exp_f32 v73, v73
    v_exp_f32 v74, v74
    v_exp_f32 v75, v75
    v_exp_f32 v76, v76
    v_exp_f32 v77, v77
    v_exp_f32 v78, v78
    v_smfmac_f32_32x32x32_bf16 v[224:239], v[60:63], v[68:75], v241
    v_exp_f32 v79, v79
    v_exp_f32 v80, v80
    v_exp_f32 v81, v81
    v_exp_f32 v82, v82
    v_exp_f32 v83, v83
    v_exp_f32 v84, v84
    v_exp_f32 v85, v85
    v_smfmac_f32_32x32x32_bf16 v[224:239], v[64:67], v[76:83], v241
    v_exp_f32 v86, v86
    v_exp_f32 v87, v87
    v_exp_f32 v88, v88
    s_waitcnt vmcnt(3)
    v_mfma_f32_32x32x16_bf16 v[68:83], v[32:35], v[20:23], 0
    ds_read_b64_tr_b16 v[116:117], v5 offset:4096
    ds_read_b64_tr_b16 v[118:119], v5 offset:5120
    ds_read_b64_tr_b16 v[120:121], v6 offset:4096
    ds_read_b64_tr_b16 v[122:123], v6 offset:5120
    ds_read_b64_tr_b16 v[124:125], v5 offset:6144
    ds_read_b64_tr_b16 v[126:127], v5 offset:7168
    ds_read_b64_tr_b16 v[128:129], v6 offset:6144
    ds_read_b64_tr_b16 v[130:131], v6 offset:7168
    s_add_u32 s76, s76, 65536
    v_exp_f32 v89, v89
    v_exp_f32 v90, v90
    v_exp_f32 v91, v91
    v_exp_f32 v92, v92
    v_exp_f32 v93, v93
    v_exp_f32 v94, v94
    v_smfmac_f32_32x32x32_bf16 v[176:191], v[60:63], v[84:91], v241
    v_exp_f32 v95, v95
    v_exp_f32 v96, v96
    v_exp_f32 v97, v97
    v_exp_f32 v98, v98
    v_exp_f32 v99, v99
    v_exp_f32 v68, v68
    v_exp_f32 v69, v69
    v_smfmac_f32_32x32x32_bf16 v[176:191], v[64:67], v[92:99], v241
    s_add_u32 s49, s66, 0x42000
    s_add_u32 s48, s66, 0x82000
    buffer_load_dwordx4 v[40:43], v2, s[16:19], s49 offen offset:0 sc0 sc1
    s_mov_b64 exec, s[90:91]
    buffer_load_dwordx4 v[60:63], v240, s[16:19], s48 offen offset:0 sc0 sc1
    buffer_load_dwordx4 v[64:67], v240, s[16:19], s48 offen offset:512 sc0 sc1
    s_mov_b64 exec, -1
    v_exp_f32 v70, v70
    v_exp_f32 v71, v71
    v_exp_f32 v72, v72
    v_mfma_f32_32x32x16_bf16 v[84:99], v[32:35], v[24:27], 0
    v_exp_f32 v73, v73
    v_exp_f32 v74, v74
    v_exp_f32 v75, v75
    v_exp_f32 v76, v76
    v_exp_f32 v77, v77
    v_exp_f32 v78, v78
    v_smfmac_f32_32x32x32_bf16 v[192:207], v[44:47], v[68:75], v241
    v_exp_f32 v79, v79
    v_exp_f32 v80, v80
    v_exp_f32 v81, v81
    v_exp_f32 v82, v82
    v_exp_f32 v83, v83
    v_exp_f32 v84, v84
    v_exp_f32 v85, v85
    v_smfmac_f32_32x32x32_bf16 v[192:207], v[48:51], v[76:83], v241
    v_exp_f32 v86, v86
    v_exp_f32 v87, v87
    v_exp_f32 v88, v88
    v_mfma_f32_32x32x16_bf16 v[68:83], v[32:35], v[28:31], 0
    s_cmp_lg_u32 s73, 3
    s_cbranch_scc1 L_w4_14
    s_add_u32 s46, s40, 1
    s_and_b32 s46, s46, 3
    s_mul_i32 s44, s46, 352256
    s_mul_i32 s46, s46, 24576
    s_add_u32 m0, s46, s74
    s_add_u32 s44, s44, s75
    buffer_load_dwordx4 v10, s[24:27], s44 offen  lds
    s_add_u32 m0, m0, 2048
    s_add_u32 s44, s44, 32
    buffer_load_dwordx4 v10, s[24:27], s44 offen  lds
    s_add_u32 m0, m0, 2048
    s_add_u32 s44, s44, 32
    buffer_load_dwordx4 v10, s[24:27], s44 offen  lds
L_w4_14:
    s_waitcnt lgkmcnt(0)
    v_exp_f32 v89, v89
    v_exp_f32 v90, v90
    v_exp_f32 v91, v91
    v_exp_f32 v92, v92
    v_exp_f32 v93, v93
    v_exp_f32 v94, v94
    v_smfmac_f32_32x32x32_bf16 v[208:223], v[44:47], v[84:91], v241
    v_exp_f32 v95, v95
    v_exp_f32 v96, v96
    v_exp_f32 v97, v97
    v_exp_f32 v98, v98
    v_exp_f32 v99, v99
    v_exp_f32 v68, v68
    v_exp_f32 v69, v69
    v_smfmac_f32_32x32x32_bf16 v[208:223], v[48:51], v[92:99], v241
    v_exp_f32 v70, v70
    v_exp_f32 v71, v71
    v_exp_f32 v72, v72
    v_mfma_f32_32x32x16_bf16 v[84:99], v[32:35], v[16:19], 0
    s_add_u32 s45, s40, 4
    s_and_b32 s45, s45, 3
    s_lshl_b32 s45, s45, 11
    s_add_u32 m0, s69, s45
    s_lshl_b32 s45, s45, 3
    s_add_u32 s44, s76, s45
    buffer_load_dwordx4 v11, s[20:23], s44 offen  lds
    s_add_u32 m0, m0, 1024
    s_add_u32 s44, s44, 8192
    buffer_load_dwordx4 v11, s[20:23], s44 offen  lds
    v_exp_f32 v73, v73
    v_exp_f32 v74, v74
    v_exp_f32 v75, v75
    v_exp_f32 v76, v76
    v_exp_f32 v77, v77
    v_exp_f32 v78, v78
    v_smfmac_f32_32x32x32_bf16 v[224:239], v[44:47], v[68:75], v241
    v_exp_f32 v79, v79
    v_exp_f32 v80, v80
    v_exp_f32 v81, v81
    v_exp_f32 v82, v82
    v_exp_f32 v83, v83
    v_exp_f32 v84, v84
    v_exp_f32 v85, v85
    v_smfmac_f32_32x32x32_bf16 v[224:239], v[48:51], v[76:83], v241
    v_exp_f32 v86, v86
    v_exp_f32 v87, v87
    v_exp_f32 v88, v88
    s_waitcnt vmcnt(5)
    v_mfma_f32_32x32x16_bf16 v[68:83], v[36:39], v[20:23], 0
    v_exp_f32 v89, v89
    v_exp_f32 v90, v90
    v_exp_f32 v91, v91
    v_exp_f32 v92, v92
    v_exp_f32 v93, v93
    v_exp_f32 v94, v94
    v_smfmac_f32_32x32x32_bf16 v[176:191], v[44:47], v[84:91], v241
    v_exp_f32 v95, v95
    v_exp_f32 v96, v96
    v_exp_f32 v97, v97
    v_exp_f32 v98, v98
    v_exp_f32 v99, v99
    s_setprio 2
    v_exp_f32 v68, v68
    v_exp_f32 v69, v69
    v_smfmac_f32_32x32x32_bf16 v[176:191], v[48:51], v[92:99], v241
    buffer_load_dwordx4 v[32:35], v2, s[16:19], s49 offen offset:1024 sc0 sc1
    s_mov_b64 exec, s[90:91]
    buffer_load_dwordx4 v[44:47], v240, s[16:19], s48 offen offset:1024 sc0 sc1
    buffer_load_dwordx4 v[48:51], v240, s[16:19], s48 offen offset:1536 sc0 sc1
    s_mov_b64 exec, -1
    v_exp_f32 v70, v70
    v_exp_f32 v71, v71
    v_exp_f32 v72, v72
    v_mfma_f32_32x32x16_bf16 v[84:99], v[36:39], v[24:27], 0
    v_exp_f32 v73, v73
    v_exp_f32 v74, v74
    v_exp_f32 v75, v75
    v_exp_f32 v76, v76
    v_exp_f32 v77, v77
    v_exp_f32 v78, v78
    v_smfmac_f32_32x32x32_bf16 v[192:207], v[52:55], v[68:75], v241
    v_exp_f32 v79, v79
    v_exp_f32 v80, v80
    v_exp_f32 v81, v81
    v_exp_f32 v82, v82
    v_exp_f32 v83, v83
    v_exp_f32 v84, v84
    v_exp_f32 v85, v85
    v_smfmac_f32_32x32x32_bf16 v[192:207], v[56:59], v[76:83], v241
    v_exp_f32 v86, v86
    v_exp_f32 v87, v87
    v_exp_f32 v88, v88
    v_mfma_f32_32x32x16_bf16 v[68:83], v[36:39], v[28:31], 0
    s_cmp_lg_u32 s73, 0
    s_cbranch_scc1 L_w4_15
    s_add_u32 s46, s40, 2
    s_and_b32 s46, s46, 3
    s_mul_i32 s44, s46, 352256
    s_mul_i32 s46, s46, 24576
    s_add_u32 m0, s46, s74
    s_add_u32 s44, s44, s75
    buffer_load_dwordx4 v10, s[24:27], s44 offen  lds
    s_add_u32 m0, m0, 2048
    s_add_u32 s44, s44, 32
    buffer_load_dwordx4 v10, s[24:27], s44 offen  lds
    s_add_u32 m0, m0, 2048
    s_add_u32 s44, s44, 32
    buffer_load_dwordx4 v10, s[24:27], s44 offen  lds
L_w4_15:
    v_exp_f32 v89, v89
    v_exp_f32 v90, v90
    v_exp_f32 v91, v91
    v_exp_f32 v92, v92
    v_exp_f32 v93, v93
    v_exp_f32 v94, v94
    v_smfmac_f32_32x32x32_bf16 v[208:223], v[52:55], v[84:91], v241
    v_exp_f32 v95, v95
    v_exp_f32 v96, v96
    v_exp_f32 v97, v97
    v_exp_f32 v98, v98
    v_exp_f32 v99, v99
    v_exp_f32 v68, v68
    v_exp_f32 v69, v69
    v_smfmac_f32_32x32x32_bf16 v[208:223], v[56:59], v[92:99], v241
    v_exp_f32 v70, v70
    v_exp_f32 v71, v71
    v_exp_f32 v72, v72
    v_mfma_f32_32x32x16_bf16 v[84:99], v[36:39], v[16:19], 0
    s_add_u32 s45, s40, 5
    s_and_b32 s45, s45, 3
    s_lshl_b32 s45, s45, 11
    s_add_u32 m0, s69, s45
    s_lshl_b32 s45, s45, 3
    s_add_u32 s44, s76, s45
    buffer_load_dwordx4 v11, s[20:23], s44 offen  lds
    s_add_u32 m0, m0, 1024
    s_add_u32 s44, s44, 8192
    buffer_load_dwordx4 v11, s[20:23], s44 offen  lds
    v_exp_f32 v73, v73
    v_exp_f32 v74, v74
    v_exp_f32 v75, v75
    v_exp_f32 v76, v76
    v_exp_f32 v77, v77
    v_exp_f32 v78, v78
    v_smfmac_f32_32x32x32_bf16 v[224:239], v[52:55], v[68:75], v241
    v_exp_f32 v79, v79
    v_exp_f32 v80, v80
    v_exp_f32 v81, v81
    v_exp_f32 v82, v82
    v_exp_f32 v83, v83
    v_exp_f32 v84, v84
    v_exp_f32 v85, v85
    v_smfmac_f32_32x32x32_bf16 v[224:239], v[56:59], v[76:83], v241
    v_exp_f32 v86, v86
    v_exp_f32 v87, v87
    v_exp_f32 v88, v88
    s_waitcnt vmcnt(7)
    v_mfma_f32_32x32x16_bf16 v[68:83], v[40:43], v[20:23], 0
    v_exp_f32 v89, v89
    v_exp_f32 v90, v90
    v_exp_f32 v91, v91
    v_exp_f32 v92, v92
    v_exp_f32 v93, v93
    v_exp_f32 v94, v94
    v_smfmac_f32_32x32x32_bf16 v[176:191], v[52:55], v[84:91], v241
    v_exp_f32 v95, v95
    v_exp_f32 v96, v96
    v_exp_f32 v97, v97
    v_exp_f32 v98, v98
    v_exp_f32 v99, v99
    v_exp_f32 v68, v68
    v_exp_f32 v69, v69
    v_smfmac_f32_32x32x32_bf16 v[176:191], v[56:59], v[92:99], v241
    buffer_load_dwordx4 v[36:39], v2, s[16:19], s49 offen offset:2048 sc0 sc1
    s_mov_b64 exec, s[90:91]
    buffer_load_dwordx4 v[52:55], v240, s[16:19], s48 offen offset:2048 sc0 sc1
    buffer_load_dwordx4 v[56:59], v240, s[16:19], s48 offen offset:2560 sc0 sc1
    s_mov_b64 exec, -1
    v_exp_f32 v70, v70
    v_exp_f32 v71, v71
    v_exp_f32 v72, v72
    v_mfma_f32_32x32x16_bf16 v[84:99], v[40:43], v[24:27], 0
    s_cmp_lg_u32 s73, 1
    s_cbranch_scc1 L_w4_16
    s_add_u32 s46, s40, 2
    s_and_b32 s46, s46, 3
    s_mul_i32 s44, s46, 352256
    s_mul_i32 s46, s46, 24576
    s_add_u32 m0, s46, s74
    s_add_u32 s44, s44, s75
    buffer_load_dwordx4 v10, s[24:27], s44 offen  lds
    s_add_u32 m0, m0, 2048
    s_add_u32 s44, s44, 32
    buffer_load_dwordx4 v10, s[24:27], s44 offen  lds
    s_add_u32 m0, m0, 2048
    s_add_u32 s44, s44, 32
    buffer_load_dwordx4 v10, s[24:27], s44 offen  lds
L_w4_16:
    v_exp_f32 v73, v73
    v_exp_f32 v74, v74
    v_exp_f32 v75, v75
    v_exp_f32 v76, v76
    v_exp_f32 v77, v77
    v_exp_f32 v78, v78
    v_smfmac_f32_32x32x32_bf16 v[192:207], v[60:63], v[68:75], v241
    v_exp_f32 v79, v79
    v_exp_f32 v80, v80
    v_exp_f32 v81, v81
    v_exp_f32 v82, v82
    v_exp_f32 v83, v83
    v_exp_f32 v84, v84
    v_exp_f32 v85, v85
    v_smfmac_f32_32x32x32_bf16 v[192:207], v[64:67], v[76:83], v241
    v_exp_f32 v86, v86
    v_exp_f32 v87, v87
    v_exp_f32 v88, v88
    v_mfma_f32_32x32x16_bf16 v[68:83], v[40:43], v[28:31], 0
    v_exp_f32 v89, v89
    v_exp_f32 v90, v90
    v_exp_f32 v91, v91
    v_exp_f32 v92, v92
    v_exp_f32 v93, v93
    v_exp_f32 v94, v94
    v_smfmac_f32_32x32x32_bf16 v[208:223], v[60:63], v[84:91], v241
    v_exp_f32 v95, v95
    v_exp_f32 v96, v96
    v_exp_f32 v97, v97
    v_exp_f32 v98, v98
    v_exp_f32 v99, v99
    v_exp_f32 v68, v68
    v_exp_f32 v69, v69
    v_smfmac_f32_32x32x32_bf16 v[208:223], v[64:67], v[92:99], v241
    v_exp_f32 v70, v70
    v_exp_f32 v71, v71
    v_exp_f32 v72, v72
    v_mfma_f32_32x32x16_bf16 v[84:99], v[40:43], v[16:19], 0
    s_add_u32 s45, s40, 6
    s_and_b32 s45, s45, 3
    s_lshl_b32 s45, s45, 11
    s_add_u32 m0, s69, s45
    s_lshl_b32 s45, s45, 3
    s_add_u32 s44, s76, s45
    buffer_load_dwordx4 v11, s[20:23], s44 offen  lds
    s_add_u32 m0, m0, 1024
    s_add_u32 s44, s44, 8192
    buffer_load_dwordx4 v11, s[20:23], s44 offen  lds
    v_exp_f32 v73, v73
    v_exp_f32 v74, v74
    v_exp_f32 v75, v75
    v_exp_f32 v76, v76
    v_exp_f32 v77, v77
    v_exp_f32 v78, v78
    v_smfmac_f32_32x32x32_bf16 v[224:239], v[60:63], v[68:75], v241
    v_exp_f32 v79, v79
    v_exp_f32 v80, v80
    v_exp_f32 v81, v81
    v_exp_f32 v82, v82
    v_exp_f32 v83, v83
    v_exp_f32 v84, v84
    v_exp_f32 v85, v85
    v_smfmac_f32_32x32x32_bf16 v[224:239], v[64:67], v[76:83], v241
    v_exp_f32 v86, v86
    v_exp_f32 v87, v87
    v_exp_f32 v88, v88
    s_waitcnt vmcnt(7)
    v_mfma_f32_32x32x16_bf16 v[68:83], v[32:35], v[20:23], 0
    v_exp_f32 v89, v89
    v_exp_f32 v90, v90
    v_exp_f32 v91, v91
    v_exp_f32 v92, v92
    v_exp_f32 v93, v93
    v_exp_f32 v94, v94
    v_smfmac_f32_32x32x32_bf16 v[176:191], v[60:63], v[84:91], v241
    v_exp_f32 v95, v95
    v_exp_f32 v96, v96
    v_exp_f32 v97, v97
    v_exp_f32 v98, v98
    v_exp_f32 v99, v99
    v_exp_f32 v68, v68
    v_exp_f32 v69, v69
    v_smfmac_f32_32x32x32_bf16 v[176:191], v[64:67], v[92:99], v241
    buffer_load_dwordx4 v[40:43], v2, s[16:19], s49 offen offset:3072 sc0 sc1
    s_mov_b64 exec, s[90:91]
    buffer_load_dwordx4 v[60:63], v240, s[16:19], s48 offen offset:3072 sc0 sc1
    buffer_load_dwordx4 v[64:67], v240, s[16:19], s48 offen offset:3584 sc0 sc1
    s_mov_b64 exec, -1
    v_exp_f32 v70, v70
    v_exp_f32 v71, v71
    v_exp_f32 v72, v72
    v_mfma_f32_32x32x16_bf16 v[84:99], v[32:35], v[24:27], 0
    s_cmp_lg_u32 s73, 2
    s_cbranch_scc1 L_w4_17
    s_add_u32 s46, s40, 2
    s_and_b32 s46, s46, 3
    s_mul_i32 s44, s46, 352256
    s_mul_i32 s46, s46, 24576
    s_add_u32 m0, s46, s74
    s_add_u32 s44, s44, s75
    buffer_load_dwordx4 v10, s[24:27], s44 offen  lds
    s_add_u32 m0, m0, 2048
    s_add_u32 s44, s44, 32
    buffer_load_dwordx4 v10, s[24:27], s44 offen  lds
    s_add_u32 m0, m0, 2048
    s_add_u32 s44, s44, 32
    buffer_load_dwordx4 v10, s[24:27], s44 offen  lds
L_w4_17:
    v_exp_f32 v73, v73
    v_exp_f32 v74, v74
    v_exp_f32 v75, v75
    v_exp_f32 v76, v76
    v_exp_f32 v77, v77
    v_exp_f32 v78, v78
    v_smfmac_f32_32x32x32_bf16 v[192:207], v[44:47], v[68:75], v241
    v_exp_f32 v79, v79
    v_exp_f32 v80, v80
    v_exp_f32 v81, v81
    v_exp_f32 v82, v82
    v_exp_f32 v83, v83
    v_exp_f32 v84, v84
    v_exp_f32 v85, v85
    v_smfmac_f32_32x32x32_bf16 v[192:207], v[48:51], v[76:83], v241
    v_exp_f32 v86, v86
    v_exp_f32 v87, v87
    v_exp_f32 v88, v88
    v_mfma_f32_32x32x16_bf16 v[68:83], v[32:35], v[28:31], 0
    v_exp_f32 v89, v89
    v_exp_f32 v90, v90
    v_exp_f32 v91, v91
    v_exp_f32 v92, v92
    v_exp_f32 v93, v93
    v_exp_f32 v94, v94
    v_smfmac_f32_32x32x32_bf16 v[208:223], v[44:47], v[84:91], v241
    v_exp_f32 v95, v95
    v_exp_f32 v96, v96
    v_exp_f32 v97, v97
    v_exp_f32 v98, v98
    v_exp_f32 v99, v99
    v_exp_f32 v68, v68
    v_exp_f32 v69, v69
    v_smfmac_f32_32x32x32_bf16 v[208:223], v[48:51], v[92:99], v241
    v_exp_f32 v70, v70
    v_exp_f32 v71, v71
    v_exp_f32 v72, v72
    v_mfma_f32_32x32x16_bf16 v[84:99], v[32:35], v[16:19], 0
    s_add_u32 s45, s40, 7
    s_and_b32 s45, s45, 3
    s_lshl_b32 s45, s45, 11
    s_add_u32 m0, s69, s45
    s_lshl_b32 s45, s45, 3
    s_add_u32 s44, s76, s45
    buffer_load_dwordx4 v11, s[20:23], s44 offen  lds
    s_add_u32 m0, m0, 1024
    s_add_u32 s44, s44, 8192
    buffer_load_dwordx4 v11, s[20:23], s44 offen  lds
    v_exp_f32 v73, v73
    v_exp_f32 v74, v74
    v_exp_f32 v75, v75
    v_exp_f32 v76, v76
    v_exp_f32 v77, v77
    v_exp_f32 v78, v78
    v_smfmac_f32_32x32x32_bf16 v[224:239], v[44:47], v[68:75], v241
    v_exp_f32 v79, v79
    v_exp_f32 v80, v80
    v_exp_f32 v81, v81
    v_exp_f32 v82, v82
    v_exp_f32 v83, v83
    v_exp_f32 v84, v84
    v_exp_f32 v85, v85
    v_smfmac_f32_32x32x32_bf16 v[224:239], v[48:51], v[76:83], v241
    v_exp_f32 v86, v86
    v_exp_f32 v87, v87
    v_exp_f32 v88, v88
    s_waitcnt vmcnt(7)
    v_mfma_f32_32x32x16_bf16 v[68:83], v[36:39], v[20:23], 0
    s_cmp_lg_u32 s73, 3
    s_cbranch_scc1 L_w4_18
    s_add_u32 s46, s40, 2
    s_and_b32 s46, s46, 3
    s_mul_i32 s44, s46, 352256
    s_mul_i32 s46, s46, 24576
    s_add_u32 m0, s46, s74
    s_add_u32 s44, s44, s75
    buffer_load_dwordx4 v10, s[24:27], s44 offen  lds
    s_add_u32 m0, m0, 2048
    s_add_u32 s44, s44, 32
    buffer_load_dwordx4 v10, s[24:27], s44 offen  lds
    s_add_u32 m0, m0, 2048
    s_add_u32 s44, s44, 32
    buffer_load_dwordx4 v10, s[24:27], s44 offen  lds
L_w4_18:
    v_exp_f32 v89, v89
    v_exp_f32 v90, v90
    v_exp_f32 v91, v91
    v_exp_f32 v92, v92
    v_exp_f32 v93, v93
    v_exp_f32 v94, v94
    v_smfmac_f32_32x32x32_bf16 v[176:191], v[44:47], v[84:91], v241
    v_exp_f32 v95, v95
    v_exp_f32 v96, v96
    v_exp_f32 v97, v97
    v_exp_f32 v98, v98
    v_exp_f32 v99, v99
    v_exp_f32 v68, v68
    v_exp_f32 v69, v69
    v_smfmac_f32_32x32x32_bf16 v[176:191], v[48:51], v[92:99], v241
    s_add_u32 s49, s66, 0x43000
    s_add_u32 s48, s66, 0x83000
    buffer_load_dwordx4 v[32:35], v2, s[16:19], s49 offen offset:0 sc0 sc1
    s_mov_b64 exec, s[90:91]
    buffer_load_dwordx4 v[44:47], v240, s[16:19], s48 offen offset:0 sc0 sc1
    buffer_load_dwordx4 v[48:51], v240, s[16:19], s48 offen offset:512 sc0 sc1
    s_mov_b64 exec, -1
    v_exp_f32 v70, v70
    v_exp_f32 v71, v71
    v_exp_f32 v72, v72
    v_mfma_f32_32x32x16_bf16 v[84:99], v[36:39], v[24:27], 0
    v_exp_f32 v73, v73
    v_exp_f32 v74, v74
    v_exp_f32 v75, v75
    v_exp_f32 v76, v76
    v_exp_f32 v77, v77
    v_exp_f32 v78, v78
    v_smfmac_f32_32x32x32_bf16 v[192:207], v[52:55], v[68:75], v241
    v_exp_f32 v79, v79
    v_exp_f32 v80, v80
    v_exp_f32 v81, v81
    v_exp_f32 v82, v82
    v_exp_f32 v83, v83
    v_exp_f32 v84, v84
    v_exp_f32 v85, v85
    v_smfmac_f32_32x32x32_bf16 v[192:207], v[56:59], v[76:83], v241
    v_exp_f32 v86, v86
    v_exp_f32 v87, v87
    v_exp_f32 v88, v88
    v_mfma_f32_32x32x16_bf16 v[68:83], v[36:39], v[28:31], 0
    v_exp_f32 v89, v89
    v_exp_f32 v90, v90
    v_exp_f32 v91, v91
    v_exp_f32 v92, v92
    v_exp_f32 v93, v93
    v_exp_f32 v94, v94
    v_smfmac_f32_32x32x32_bf16 v[208:223], v[52:55], v[84:91], v241
    v_exp_f32 v95, v95
    v_exp_f32 v96, v96
    v_exp_f32 v97, v97
    v_exp_f32 v98, v98
    v_exp_f32 v99, v99
    v_exp_f32 v68, v68
    v_exp_f32 v69, v69
    v_smfmac_f32_32x32x32_bf16 v[208:223], v[56:59], v[92:99], v241
    v_exp_f32 v70, v70
    v_exp_f32 v71, v71
    v_exp_f32 v72, v72
    v_mfma_f32_32x32x16_bf16 v[84:99], v[36:39], v[16:19], 0
    v_exp_f32 v73, v73
    v_exp_f32 v74, v74
    v_exp_f32 v75, v75
    v_exp_f32 v76, v76
    v_exp_f32 v77, v77
    v_exp_f32 v78, v78
    v_smfmac_f32_32x32x32_bf16 v[224:239], v[52:55], v[68:75], v241
    v_exp_f32 v79, v79
    v_exp_f32 v80, v80
    v_exp_f32 v81, v81
    v_exp_f32 v82, v82
    v_exp_f32 v83, v83
    v_exp_f32 v84, v84
    v_exp_f32 v85, v85
    v_smfmac_f32_32x32x32_bf16 v[224:239], v[56:59], v[76:83], v241
    v_exp_f32 v86, v86
    v_exp_f32 v87, v87
    v_exp_f32 v88, v88
    s_waitcnt vmcnt(5)
    v_mfma_f32_32x32x16_bf16 v[68:83], v[40:43], v[20:23], 0
    s_cmp_lg_u32 s73, 0
    s_cbranch_scc1 L_w4_19
    s_add_u32 s46, s40, 3
    s_and_b32 s46, s46, 3
    s_mul_i32 s44, s46, 352256
    s_mul_i32 s46, s46, 24576
    s_add_u32 m0, s46, s74
    s_add_u32 s44, s44, s75
    buffer_load_dwordx4 v10, s[24:27], s44 offen  lds
    s_add_u32 m0, m0, 2048
    s_add_u32 s44, s44, 32
    buffer_load_dwordx4 v10, s[24:27], s44 offen  lds
    s_add_u32 m0, m0, 2048
    s_add_u32 s44, s44, 32
    buffer_load_dwordx4 v10, s[24:27], s44 offen  lds
L_w4_19:
    v_exp_f32 v89, v89
    v_exp_f32 v90, v90
    v_exp_f32 v91, v91
    v_exp_f32 v92, v92
    v_exp_f32 v93, v93
    v_exp_f32 v94, v94
    v_smfmac_f32_32x32x32_bf16 v[176:191], v[52:55], v[84:91], v241
    v_exp_f32 v95, v95
    v_exp_f32 v96, v96
    v_exp_f32 v97, v97
    v_exp_f32 v98, v98
    v_exp_f32 v99, v99
    v_exp_f32 v68, v68
    v_exp_f32 v69, v69
    v_smfmac_f32_32x32x32_bf16 v[176:191], v[56:59], v[92:99], v241
    buffer_load_dwordx4 v[36:39], v2, s[16:19], s49 offen offset:1024 sc0 sc1
    s_mov_b64 exec, s[90:91]
    buffer_load_dwordx4 v[52:55], v240, s[16:19], s48 offen offset:1024 sc0 sc1
    buffer_load_dwordx4 v[56:59], v240, s[16:19], s48 offen offset:1536 sc0 sc1
    s_mov_b64 exec, -1
    v_exp_f32 v70, v70
    v_exp_f32 v71, v71
    v_exp_f32 v72, v72
    v_mfma_f32_32x32x16_bf16 v[84:99], v[40:43], v[24:27], 0
    v_exp_f32 v73, v73
    v_exp_f32 v74, v74
    v_exp_f32 v75, v75
    v_exp_f32 v76, v76
    v_exp_f32 v77, v77
    v_exp_f32 v78, v78
    v_smfmac_f32_32x32x32_bf16 v[192:207], v[60:63], v[68:75], v241
    v_exp_f32 v79, v79
    v_exp_f32 v80, v80
    v_exp_f32 v81, v81
    v_exp_f32 v82, v82
    v_exp_f32 v83, v83
    v_exp_f32 v84, v84
    v_exp_f32 v85, v85
    v_smfmac_f32_32x32x32_bf16 v[192:207], v[64:67], v[76:83], v241
    v_exp_f32 v86, v86
    v_exp_f32 v87, v87
    v_exp_f32 v88, v88
    v_mfma_f32_32x32x16_bf16 v[68:83], v[40:43], v[28:31], 0
    v_exp_f32 v89, v89
    v_exp_f32 v90, v90
    v_exp_f32 v91, v91
    v_exp_f32 v92, v92
    v_exp_f32 v93, v93
    v_exp_f32 v94, v94
    v_smfmac_f32_32x32x32_bf16 v[208:223], v[60:63], v[84:91], v241
    v_exp_f32 v95, v95
    v_exp_f32 v96, v96
    v_exp_f32 v97, v97
    v_exp_f32 v98, v98
    v_exp_f32 v99, v99
    v_exp_f32 v68, v68
    v_exp_f32 v69, v69
    v_smfmac_f32_32x32x32_bf16 v[208:223], v[64:67], v[92:99], v241
    v_exp_f32 v70, v70
    v_exp_f32 v71, v71
    v_exp_f32 v72, v72
    v_mfma_f32_32x32x16_bf16 v[84:99], v[40:43], v[16:19], 0
    s_cmp_lg_u32 s73, 1
    s_cbranch_scc1 L_w4_20
    s_add_u32 s46, s40, 3
    s_and_b32 s46, s46, 3
    s_mul_i32 s44, s46, 352256
    s_mul_i32 s46, s46, 24576
    s_add_u32 m0, s46, s74
    s_add_u32 s44, s44, s75
    buffer_load_dwordx4 v10, s[24:27], s44 offen  lds
    s_add_u32 m0, m0, 2048
    s_add_u32 s44, s44, 32
    buffer_load_dwordx4 v10, s[24:27], s44 offen  lds
    s_add_u32 m0, m0, 2048
    s_add_u32 s44, s44, 32
    buffer_load_dwordx4 v10, s[24:27], s44 offen  lds
L_w4_20:
    s_waitcnt vmcnt(6)
    ds_read_b64_tr_b16 v[132:133], v5 offset:0
    ds_read_b64_tr_b16 v[134:135], v5 offset:1024
    ds_read_b64_tr_b16 v[136:137], v6 offset:0
    ds_read_b64_tr_b16 v[138:139], v6 offset:1024
    ds_read_b64_tr_b16 v[140:141], v5 offset:2048
    ds_read_b64_tr_b16 v[142:143], v5 offset:3072
    ds_read_b64_tr_b16 v[144:145], v6 offset:2048
    ds_read_b64_tr_b16 v[146:147], v6 offset:3072
    v_exp_f32 v73, v73
    v_exp_f32 v74, v74
    v_exp_f32 v75, v75
    v_exp_f32 v76, v76
    v_exp_f32 v77, v77
    v_exp_f32 v78, v78
    v_smfmac_f32_32x32x32_bf16 v[224:239], v[60:63], v[68:75], v241
    v_exp_f32 v79, v79
    v_exp_f32 v80, v80
    v_exp_f32 v81, v81
    v_exp_f32 v82, v82
    v_exp_f32 v83, v83
    v_exp_f32 v84, v84
    v_exp_f32 v85, v85
    v_smfmac_f32_32x32x32_bf16 v[224:239], v[64:67], v[76:83], v241
    v_exp_f32 v86, v86
    v_exp_f32 v87, v87
    v_exp_f32 v88, v88
    s_waitcnt vmcnt(3)
    v_mfma_f32_32x32x16_bf16 v[68:83], v[32:35], v[20:23], 0
    ds_read_b64_tr_b16 v[148:149], v5 offset:4096
    ds_read_b64_tr_b16 v[150:151], v5 offset:5120
    ds_read_b64_tr_b16 v[152:153], v6 offset:4096
    ds_read_b64_tr_b16 v[154:155], v6 offset:5120
    ds_read_b64_tr_b16 v[156:157], v5 offset:6144
    ds_read_b64_tr_b16 v[158:159], v5 offset:7168
    ds_read_b64_tr_b16 v[160:161], v6 offset:6144
    ds_read_b64_tr_b16 v[162:163], v6 offset:7168
    v_exp_f32 v89, v89
    v_exp_f32 v90, v90
    v_exp_f32 v91, v91
    v_exp_f32 v92, v92
    v_exp_f32 v93, v93
    v_exp_f32 v94, v94
    v_smfmac_f32_32x32x32_bf16 v[176:191], v[60:63], v[84:91], v241
    v_exp_f32 v95, v95
    v_exp_f32 v96, v96
    v_exp_f32 v97, v97
    v_exp_f32 v98, v98
    v_exp_f32 v99, v99
    v_exp_f32 v68, v68
    v_exp_f32 v69, v69
    v_smfmac_f32_32x32x32_bf16 v[176:191], v[64:67], v[92:99], v241
    buffer_load_dwordx4 v[40:43], v2, s[16:19], s49 offen offset:2048 sc0 sc1
    s_mov_b64 exec, s[90:91]
    buffer_load_dwordx4 v[60:63], v240, s[16:19], s48 offen offset:2048 sc0 sc1
    buffer_load_dwordx4 v[64:67], v240, s[16:19], s48 offen offset:2560 sc0 sc1
    s_mov_b64 exec, -1
    v_exp_f32 v70, v70
    v_exp_f32 v71, v71
    v_exp_f32 v72, v72
    v_mfma_f32_32x32x16_bf16 v[84:99], v[32:35], v[24:27], 0
    v_exp_f32 v73, v73
    v_exp_f32 v74, v74
    v_exp_f32 v75, v75
    v_exp_f32 v76, v76
    v_exp_f32 v77, v77
    v_exp_f32 v78, v78
    v_smfmac_f32_32x32x32_bf16 v[192:207], v[44:47], v[68:75], v241
    v_exp_f32 v79, v79
    v_exp_f32 v80, v80
    v_exp_f32 v81, v81
    v_exp_f32 v82, v82
    v_exp_f32 v83, v83
    v_exp_f32 v84, v84
    v_exp_f32 v85, v85
    v_smfmac_f32_32x32x32_bf16 v[192:207], v[48:51], v[76:83], v241
    v_exp_f32 v86, v86
    v_exp_f32 v87, v87
    v_exp_f32 v88, v88
    v_mfma_f32_32x32x16_bf16 v[68:83], v[32:35], v[28:31], 0
    buffer_load_dwordx4 v[164:167], v175, s[32:35], s80 offen
    s_mov_b64 exec, 0xffff
    buffer_load_dwordx4 v[164:167], v2, s[16:19], s81 offen
    s_mov_b64 exec, -1
    v_exp_f32 v89, v89
    v_exp_f32 v90, v90
    v_exp_f32 v91, v91
    v_exp_f32 v92, v92
    v_exp_f32 v93, v93
    v_exp_f32 v94, v94
    v_smfmac_f32_32x32x32_bf16 v[208:223], v[44:47], v[84:91], v241
    v_exp_f32 v95, v95
    v_exp_f32 v96, v96
    v_exp_f32 v97, v97
    v_exp_f32 v98, v98
    v_exp_f32 v99, v99
    s_setprio 1
    v_exp_f32 v68, v68
    v_exp_f32 v69, v69
    v_smfmac_f32_32x32x32_bf16 v[208:223], v[48:51], v[92:99], v241
    v_exp_f32 v70, v70
    v_exp_f32 v71, v71
    v_exp_f32 v72, v72
    v_mfma_f32_32x32x16_bf16 v[84:99], v[32:35], v[16:19], 0
    s_cmp_lg_u32 s73, 2
    s_cbranch_scc1 L_w4_21
    s_add_u32 s46, s40, 3
    s_and_b32 s46, s46, 3
    s_mul_i32 s44, s46, 352256
    s_mul_i32 s46, s46, 24576
    s_add_u32 m0, s46, s74
    s_add_u32 s44, s44, s75
    buffer_load_dwordx4 v10, s[24:27], s44 offen  lds
    s_add_u32 m0, m0, 2048
    s_add_u32 s44, s44, 32
    buffer_load_dwordx4 v10, s[24:27], s44 offen  lds
    s_add_u32 m0, m0, 2048
    s_add_u32 s44, s44, 32
    buffer_load_dwordx4 v10, s[24:27], s44 offen  lds
L_w4_21:
    s_add_u32 s45, s40, 0
    s_mul_i32 s44, s45, 86
    s_lshr_b32 s44, s44, 8
    s_mul_i32 s44, s44, 3
    s_sub_u32 s45, s45, s44
    s_lshl_b32 s45, s45, 19
    s_lshl_b32 s44, s41, 13
    s_add_u32 s44, s44, s68
    s_add_u32 s44, s44, s45
    buffer_load_dwordx4 v[164:167], v2, s[28:31], s44 offen
    s_add_u32 s44, s44, 262144
    buffer_load_dwordx4 v[164:167], v2, s[28:31], s44 offen
    v_exp_f32 v73, v73
    v_exp_f32 v74, v74
    v_exp_f32 v75, v75
    v_exp_f32 v76, v76
    v_exp_f32 v77, v77
    v_exp_f32 v78, v78
    v_smfmac_f32_32x32x32_bf16 v[224:239], v[44:47], v[68:75], v241
    v_exp_f32 v79, v79
    v_exp_f32 v80, v80
    v_exp_f32 v81, v81
    v_exp_f32 v82, v82
    v_exp_f32 v83, v83
    v_exp_f32 v84, v84
    v_exp_f32 v85, v85
    v_smfmac_f32_32x32x32_bf16 v[224:239], v[48:51], v[76:83], v241
    v_exp_f32 v86, v86
    v_exp_f32 v87, v87
    v_exp_f32 v88, v88
    s_waitcnt vmcnt(7)
    v_mfma_f32_32x32x16_bf16 v[68:83], v[36:39], v[20:23], 0
    v_exp_f32 v89, v89
    v_exp_f32 v90, v90
    v_exp_f32 v91, v91
    v_exp_f32 v92, v92
    v_exp_f32 v93, v93
    v_exp_f32 v94, v94
    v_smfmac_f32_32x32x32_bf16 v[176:191], v[44:47], v[84:91], v241
    v_exp_f32 v95, v95
    v_exp_f32 v96, v96
    v_exp_f32 v97, v97
    v_exp_f32 v98, v98
    v_exp_f32 v99, v99
    v_exp_f32 v68, v68
    v_exp_f32 v69, v69
    v_smfmac_f32_32x32x32_bf16 v[176:191], v[48:51], v[92:99], v241
    buffer_load_dwordx4 v[32:35], v2, s[16:19], s49 offen offset:3072 sc0 sc1
    s_mov_b64 exec, s[90:91]
    buffer_load_dwordx4 v[44:47], v240, s[16:19], s48 offen offset:3072 sc0 sc1
    buffer_load_dwordx4 v[48:51], v240, s[16:19], s48 offen offset:3584 sc0 sc1
    s_mov_b64 exec, -1
    v_exp_f32 v70, v70
    v_exp_f32 v71, v71
    v_exp_f32 v72, v72
    v_mfma_f32_32x32x16_bf16 v[84:99], v[36:39], v[24:27], 0
    s_waitcnt lgkmcnt(0)
    v_exp_f32 v73, v73
    v_exp_f32 v74, v74
    v_exp_f32 v75, v75
    v_exp_f32 v76, v76
    v_exp_f32 v77, v77
    v_exp_f32 v78, v78
    v_smfmac_f32_32x32x32_bf16 v[192:207], v[52:55], v[68:75], v241
    v_exp_f32 v79, v79
    v_exp_f32 v80, v80
    v_exp_f32 v81, v81
    v_exp_f32 v82, v82
    v_exp_f32 v83, v83
    v_exp_f32 v84, v84
    v_exp_f32 v85, v85
    v_smfmac_f32_32x32x32_bf16 v[192:207], v[56:59], v[76:83], v241
    v_exp_f32 v86, v86
    v_exp_f32 v87, v87
    v_exp_f32 v88, v88
    v_mfma_f32_32x32x16_bf16 v[68:83], v[36:39], v[28:31], 0
    s_cmp_lg_u32 s73, 3
    s_cbranch_scc1 L_w4_22
    s_add_u32 s46, s40, 3
    s_and_b32 s46, s46, 3
    s_mul_i32 s44, s46, 352256
    s_mul_i32 s46, s46, 24576
    s_add_u32 m0, s46, s74
    s_add_u32 s44, s44, s75
    buffer_load_dwordx4 v10, s[24:27], s44 offen  lds
    s_add_u32 m0, m0, 2048
    s_add_u32 s44, s44, 32
    buffer_load_dwordx4 v10, s[24:27], s44 offen  lds
    s_add_u32 m0, m0, 2048
    s_add_u32 s44, s44, 32
    buffer_load_dwordx4 v10, s[24:27], s44 offen  lds
L_w4_22:
    v_exp_f32 v89, v89
    v_exp_f32 v90, v90
    v_exp_f32 v91, v91
    v_exp_f32 v92, v92
    v_exp_f32 v93, v93
    v_exp_f32 v94, v94
    v_smfmac_f32_32x32x32_bf16 v[208:223], v[52:55], v[84:91], v241
    v_exp_f32 v95, v95
    v_exp_f32 v96, v96
    v_exp_f32 v97, v97
    v_exp_f32 v98, v98
    v_exp_f32 v99, v99
    v_exp_f32 v68, v68
    v_exp_f32 v69, v69
    v_smfmac_f32_32x32x32_bf16 v[208:223], v[56:59], v[92:99], v241
    v_exp_f32 v70, v70
    v_exp_f32 v71, v71
    v_exp_f32 v72, v72
    v_mfma_f32_32x32x16_bf16 v[84:99], v[36:39], v[16:19], 0
    s_add_u32 s45, s40, 1
    s_mul_i32 s44, s45, 86
    s_lshr_b32 s44, s44, 8
    s_mul_i32 s44, s44, 3
    s_sub_u32 s45, s45, s44
    s_lshl_b32 s45, s45, 19
    s_lshl_b32 s44, s41, 13
    s_add_u32 s44, s44, s68
    s_add_u32 s44, s44, s45
    buffer_load_dwordx4 v[164:167], v2, s[28:31], s44 offen
    s_add_u32 s44, s44, 262144
    buffer_load_dwordx4 v[164:167], v2, s[28:31], s44 offen
    v_exp_f32 v73, v73
    v_exp_f32 v74, v74
    v_exp_f32 v75, v75
    v_exp_f32 v76, v76
    v_exp_f32 v77, v77
    v_exp_f32 v78, v78
    v_smfmac_f32_32x32x32_bf16 v[224:239], v[52:55], v[68:75], v241
    v_exp_f32 v79, v79
    v_exp_f32 v80, v80
    v_exp_f32 v81, v81
    v_exp_f32 v82, v82
    v_exp_f32 v83, v83
    v_exp_f32 v84, v84
    v_exp_f32 v85, v85
    v_smfmac_f32_32x32x32_bf16 v[224:239], v[56:59], v[76:83], v241
    v_exp_f32 v86, v86
    v_exp_f32 v87, v87
    v_exp_f32 v88, v88
    s_waitcnt vmcnt(9)
    v_mfma_f32_32x32x16_bf16 v[68:83], v[40:43], v[20:23], 0
    v_exp_f32 v89, v89
    v_exp_f32 v90, v90
    v_exp_f32 v91, v91
    v_exp_f32 v92, v92
    v_exp_f32 v93, v93
    v_exp_f32 v94, v94
    v_smfmac_f32_32x32x32_bf16 v[176:191], v[52:55], v[84:91], v241
    v_exp_f32 v95, v95
    v_exp_f32 v96, v96
    v_exp_f32 v97, v97
    v_exp_f32 v98, v98
    v_exp_f32 v99, v99
    v_exp_f32 v68, v68
    v_exp_f32 v69, v69
    v_smfmac_f32_32x32x32_bf16 v[176:191], v[56:59], v[92:99], v241
    v_exp_f32 v70, v70
    v_exp_f32 v71, v71
    v_exp_f32 v72, v72
    v_mfma_f32_32x32x16_bf16 v[84:99], v[40:43], v[24:27], 0
    v_exp_f32 v73, v73
    v_exp_f32 v74, v74
    v_exp_f32 v75, v75
    v_exp_f32 v76, v76
    v_exp_f32 v77, v77
    v_exp_f32 v78, v78
    v_smfmac_f32_32x32x32_bf16 v[192:207], v[60:63], v[68:75], v241
    v_exp_f32 v79, v79
    v_exp_f32 v80, v80
    v_exp_f32 v81, v81
    v_exp_f32 v82, v82
    v_exp_f32 v83, v83
    v_exp_f32 v84, v84
    v_exp_f32 v85, v85
    v_smfmac_f32_32x32x32_bf16 v[192:207], v[64:67], v[76:83], v241
    v_exp_f32 v86, v86
    v_exp_f32 v87, v87
    v_exp_f32 v88, v88
    v_mfma_f32_32x32x16_bf16 v[68:83], v[40:43], v[28:31], 0
    v_exp_f32 v89, v89
    v_exp_f32 v90, v90
    v_exp_f32 v91, v91
    v_exp_f32 v92, v92
    v_exp_f32 v93, v93
    v_exp_f32 v94, v94
    v_smfmac_f32_32x32x32_bf16 v[208:223], v[60:63], v[84:91], v241
    v_exp_f32 v95, v95
    v_exp_f32 v96, v96
    v_exp_f32 v97, v97
    v_exp_f32 v98, v98
    v_exp_f32 v99, v99
    v_exp_f32 v68, v68
    v_exp_f32 v69, v69
    v_smfmac_f32_32x32x32_bf16 v[208:223], v[64:67], v[92:99], v241
    v_exp_f32 v70, v70
    v_exp_f32 v71, v71
    v_exp_f32 v72, v72
    v_mfma_f32_32x32x16_bf16 v[84:99], v[40:43], v[16:19], 0
    s_add_u32 s45, s40, 2
    s_mul_i32 s44, s45, 86
    s_lshr_b32 s44, s44, 8
    s_mul_i32 s44, s44, 3
    s_sub_u32 s45, s45, s44
    s_lshl_b32 s45, s45, 19
    s_lshl_b32 s44, s41, 13
    s_add_u32 s44, s44, s68
    s_add_u32 s44, s44, s45
    buffer_load_dwordx4 v[164:167], v2, s[28:31], s44 offen
    s_add_u32 s44, s44, 262144
    buffer_load_dwordx4 v[164:167], v2, s[28:31], s44 offen
    v_exp_f32 v73, v73
    v_exp_f32 v74, v74
    v_exp_f32 v75, v75
    v_exp_f32 v76, v76
    v_exp_f32 v77, v77
    v_exp_f32 v78, v78
    v_smfmac_f32_32x32x32_bf16 v[224:239], v[60:63], v[68:75], v241
    v_exp_f32 v79, v79
    v_exp_f32 v80, v80
    v_exp_f32 v81, v81
    v_exp_f32 v82, v82
    v_exp_f32 v83, v83
    v_exp_f32 v84, v84
    v_exp_f32 v85, v85
    v_smfmac_f32_32x32x32_bf16 v[224:239], v[64:67], v[76:83], v241
    v_exp_f32 v86, v86
    v_exp_f32 v87, v87
    v_exp_f32 v88, v88
    s_waitcnt vmcnt(4)
    v_mfma_f32_32x32x16_bf16 v[68:83], v[32:35], v[20:23], 0
    v_exp_f32 v89, v89
    v_exp_f32 v90, v90
    v_exp_f32 v91, v91
    v_exp_f32 v92, v92
    v_exp_f32 v93, v93
    v_exp_f32 v94, v94
    v_smfmac_f32_32x32x32_bf16 v[176:191], v[60:63], v[84:91], v241
    v_exp_f32 v95, v95
    v_exp_f32 v96, v96
    v_exp_f32 v97, v97
    v_exp_f32 v98, v98
    v_exp_f32 v99, v99
    v_exp_f32 v68, v68
    v_exp_f32 v69, v69
    v_smfmac_f32_32x32x32_bf16 v[176:191], v[64:67], v[92:99], v241
    v_exp_f32 v70, v70
    v_exp_f32 v71, v71
    v_exp_f32 v72, v72
    v_mfma_f32_32x32x16_bf16 v[84:99], v[32:35], v[24:27], 0
    v_exp_f32 v73, v73
    v_exp_f32 v74, v74
    v_exp_f32 v75, v75
    v_exp_f32 v76, v76
    v_exp_f32 v77, v77
    v_exp_f32 v78, v78
    v_smfmac_f32_32x32x32_bf16 v[192:207], v[44:47], v[68:75], v241
    v_exp_f32 v79, v79
    v_exp_f32 v80, v80
    v_exp_f32 v81, v81
    v_exp_f32 v82, v82
    v_exp_f32 v83, v83
    s_setprio 0
    v_exp_f32 v84, v84
    v_exp_f32 v85, v85
    v_smfmac_f32_32x32x32_bf16 v[192:207], v[48:51], v[76:83], v241
    v_exp_f32 v86, v86
    v_exp_f32 v87, v87
    v_exp_f32 v88, v88
    v_mfma_f32_32x32x16_bf16 v[68:83], v[32:35], v[28:31], 0
    v_exp_f32 v89, v89
    v_exp_f32 v90, v90
    v_exp_f32 v91, v91
    v_exp_f32 v92, v92
    v_exp_f32 v93, v93
    v_exp_f32 v94, v94
    v_smfmac_f32_32x32x32_bf16 v[208:223], v[44:47], v[84:91], v241
    v_exp_f32 v95, v95
    v_exp_f32 v96, v96
    v_exp_f32 v97, v97
    v_exp_f32 v98, v98
    v_exp_f32 v99, v99
    v_exp_f32 v68, v68
    v_exp_f32 v69, v69
    v_smfmac_f32_32x32x32_bf16 v[208:223], v[48:51], v[92:99], v241
    v_exp_f32 v70, v70
    v_exp_f32 v71, v71
    v_exp_f32 v72, v72
    v_mfma_f32_32x32x16_bf16 v[84:99], v[32:35], v[16:19], 0
    ds_write_b128 v15, v[192:195] offset:0
    ds_write_b128 v15, v[196:199] offset:1024
    ds_write_b32 v251, v200 offset:2048
    v_exp_f32 v73, v73
    v_exp_f32 v74, v74
    v_exp_f32 v75, v75
    v_exp_f32 v76, v76
    v_exp_f32 v77, v77
    v_exp_f32 v78, v78
    v_smfmac_f32_32x32x32_bf16 v[224:239], v[44:47], v[68:75], v241
    v_exp_f32 v79, v79
    v_exp_f32 v80, v80
    v_exp_f32 v81, v81
    v_exp_f32 v82, v82
    v_exp_f32 v83, v83
    v_exp_f32 v84, v84
    v_exp_f32 v85, v85
    v_smfmac_f32_32x32x32_bf16 v[224:239], v[48:51], v[76:83], v241
    v_exp_f32 v86, v86
    v_exp_f32 v87, v87
    v_exp_f32 v88, v88
    ds_write_b128 v15, v[208:211] offset:2304
    ds_write_b128 v15, v[212:215] offset:3328
    ds_write_b32 v251, v216 offset:4352
    v_exp_f32 v89, v89
    v_exp_f32 v90, v90
    v_exp_f32 v91, v91
    v_exp_f32 v92, v92
    v_exp_f32 v93, v93
    v_exp_f32 v94, v94
    v_smfmac_f32_32x32x32_bf16 v[176:191], v[44:47], v[84:91], v241
    v_exp_f32 v95, v95
    v_exp_f32 v96, v96
    v_exp_f32 v97, v97
    v_exp_f32 v98, v98
    v_exp_f32 v99, v99
    ds_write_b128 v15, v[224:227] offset:4608
    ds_write_b128 v15, v[228:231] offset:5632
    ds_write_b32 v251, v232 offset:6656
    v_smfmac_f32_32x32x32_bf16 v[176:191], v[48:51], v[92:99], v241
    v_xor_b32 v68, 16384, v251
    v_xor_b32 v69, 32768, v251
    v_xor_b32 v70, 49152, v251
    s_waitcnt vmcnt(0) lgkmcnt(0)
    s_barrier
    ds_read_b128 v[192:195], v12
    ds_read_b128 v[196:199], v12 offset:1024
    ds_read_b32 v200, v68 offset:2048
    ds_read_b128 v[208:211], v13
    ds_read_b128 v[212:215], v13 offset:1024
    ds_read_b32 v216, v69 offset:4352
    ds_read_b128 v[224:227], v14
    ds_read_b128 v[228:231], v14 offset:1024
    ds_read_b32 v232, v70 offset:6656
    s_mov_b32 s66, 0
    s_waitcnt lgkmcnt(6)
    v_pk_add_f32 v[176:177], v[176:177], v[192:193]
    v_pk_add_f32 v[178:179], v[178:179], v[194:195]
    v_pk_add_f32 v[180:181], v[180:181], v[196:197]
    v_pk_add_f32 v[182:183], v[182:183], v[198:199]
    v_add_f32 v184, v184, v200
    s_waitcnt lgkmcnt(0)
    v_add_f32 v216, v216, v232
    v_pk_add_f32 v[208:209], v[208:209], v[224:225]
    v_pk_add_f32 v[210:211], v[210:211], v[226:227]
    v_pk_add_f32 v[212:213], v[212:213], v[228:229]
    v_pk_add_f32 v[214:215], v[214:215], v[230:231]
    v_add_f32 v184, v184, v216
    v_pk_add_f32 v[176:177], v[176:177], v[208:209]
    v_pk_add_f32 v[178:179], v[178:179], v[210:211]
    v_pk_add_f32 v[180:181], v[180:181], v[212:213]
    v_pk_add_f32 v[182:183], v[182:183], v[214:215]
L_att_fin:
    v_rcp_f32 v192, v184
    s_mov_b32 s44, 0x21800000
    s_mov_b32 s45, 0x5d800000
    v_cmp_le_f32 s[4:5], s44, v184
    v_cmp_ge_f32 s[6:7], s45, v184
    v_mov_b32 v5, 0
    v_pk_mul_f32 v[176:177], v[176:177], v[192:193] op_sel_hi:[1,0]
    v_pk_mul_f32 v[178:179], v[178:179], v[192:193] op_sel_hi:[1,0]
    v_pk_mul_f32 v[180:181], v[180:181], v[192:193] op_sel_hi:[1,0]
    v_pk_mul_f32 v[182:183], v[182:183], v[192:193] op_sel_hi:[1,0]
    v_cvt_pk_bf16_f32 v164, v176, v177
    v_cvt_pk_bf16_f32 v165, v178, v179
    v_cvt_pk_bf16_f32 v166, v180, v181
    v_cvt_pk_bf16_f32 v167, v182, v183
    v_fmac_f32 v5, 0, v176
    v_fmac_f32 v5, 0, v177
    v_fmac_f32 v5, 0, v178
    v_fmac_f32 v5, 0, v179
    v_fmac_f32 v5, 0, v180
    v_fmac_f32 v5, 0, v181
    v_fmac_f32 v5, 0, v182
    v_fmac_f32 v5, 0, v183
    s_and_b64 s[4:5], s[4:5], s[6:7]
    v_cmp_o_f32 vcc, v5, v5
    s_mul_i32 s46, s42, 12288
    s_nop 0
    s_and_b64 s[4:5], s[4:5], vcc
    s_cmp_eq_u64 s[4:5], exec
    s_cbranch_scc1 L_att_store
    s_cmp_eq_u32 s66, 0
    s_cbranch_scc1 L_att_slow
L_att_store:
    buffer_store_dwordx4 v[164:167], v2, s[16:19], s86 offen sc0 sc1
    v_add_u32 v7, s46, v242
    ds_read_b64_tr_b16 v[32:33], v7 offset:0
    ds_read_b64_tr_b16 v[34:35], v7 offset:256
    ds_read_b64_tr_b16 v[36:37], v7 offset:2048
    ds_read_b64_tr_b16 v[38:39], v7 offset:2304
    ds_read_b64_tr_b16 v[40:41], v7 offset:4096
    ds_read_b64_tr_b16 v[42:43], v7 offset:4352
    ds_read_b64_tr_b16 v[44:45], v7 offset:512
    ds_read_b64_tr_b16 v[46:47], v7 offset:768
    ds_read_b64_tr_b16 v[48:49], v7 offset:2560
    ds_read_b64_tr_b16 v[50:51], v7 offset:2816
    ds_read_b64_tr_b16 v[52:53], v7 offset:4608
    ds_read_b64_tr_b16 v[54:55], v7 offset:4864
    s_waitcnt lgkmcnt(6)
    v_mfma_f32_16x16x32_bf16 v[20:23], v[252:255], v[32:35], 0
    v_mfma_f32_16x16x32_bf16 v[24:27], v[252:255], v[36:39], 0
    v_mfma_f32_16x16x32_bf16 v[28:31], v[252:255], v[40:43], 0
    ds_read_b64_tr_b16 v[56:57], v7 offset:6144
    ds_read_b64_tr_b16 v[58:59], v7 offset:6400
    ds_read_b64_tr_b16 v[60:61], v7 offset:8192
    ds_read_b64_tr_b16 v[62:63], v7 offset:8448
    ds_read_b64_tr_b16 v[64:65], v7 offset:10240
    ds_read_b64_tr_b16 v[66:67], v7 offset:10496
    s_waitcnt lgkmcnt(6)
    v_mfma_f32_16x16x32_bf16 v[20:23], v[252:255], v[44:47], v[20:23]
    v_mfma_f32_16x16x32_bf16 v[24:27], v[252:255], v[48:51], v[24:27]
    v_mfma_f32_16x16x32_bf16 v[28:31], v[252:255], v[52:55], v[28:31]
    ds_read_b64_tr_b16 v[68:69], v7 offset:6656
    ds_read_b64_tr_b16 v[70:71], v7 offset:6912
    ds_read_b64_tr_b16 v[72:73], v7 offset:8704
    ds_read_b64_tr_b16 v[74:75], v7 offset:8960
    ds_read_b64_tr_b16 v[76:77], v7 offset:10752
    ds_read_b64_tr_b16 v[78:79], v7 offset:11008
    s_waitcnt lgkmcnt(6)
    v_mfma_f32_16x16x32_bf16 v[20:23], v[252:255], v[56:59], v[20:23]
    v_mfma_f32_16x16x32_bf16 v[24:27], v[252:255], v[60:63], v[24:27]
    v_mfma_f32_16x16x32_bf16 v[28:31], v[252:255], v[64:67], v[28:31]
    s_waitcnt lgkmcnt(0)
    v_mfma_f32_16x16x32_bf16 v[20:23], v[252:255], v[68:71], v[20:23]
    v_mfma_f32_16x16x32_bf16 v[24:27], v[252:255], v[72:75], v[24:27]
    v_mfma_f32_16x16x32_bf16 v[28:31], v[252:255], v[76:79], v[28:31]
    s_cmp_lg_u32 s42, 7
    s_cbranch_scc1 L_sig_23
    v_mov_b32 v4, s43
    v_lshlrev_b32 v3, 2, v1
    s_mov_b64 exec, 1
    s_waitcnt vmcnt(0)
    s_barrier
    buffer_store_dword v4, v3, s[16:19], s38 offen sc0 sc1
    s_mov_b64 exec, -1
    s_branch L_sig_23_j
L_sig_23:
    s_waitcnt vmcnt(0)
    s_barrier
L_sig_23_j:
    s_add_u32 m0, s69, 0
    s_add_u32 s44, s78, 0
    buffer_load_dwordx4 v11, s[28:31], s44 offen lds
    s_add_u32 m0, s69, 1024
    s_add_u32 s44, s78, 8192
    buffer_load_dwordx4 v11, s[28:31], s44 offen lds
    s_add_u32 m0, s69, 2304
    s_add_u32 s44, s78, 65536
    buffer_load_dwordx4 v11, s[28:31], s44 offen lds
    s_add_u32 m0, s69, 3328
    s_add_u32 s44, s78, 73728
    buffer_load_dwordx4 v11, s[28:31], s44 offen lds
    s_add_u32 m0, s69, 6912
    s_mov_b64 exec, 0xffff
    ds_write_b32 v251, v20 offset:2048
    ds_write_b32 v251, v21 offset:2112
    ds_write_b32 v251, v24 offset:4352
    ds_write_b32 v251, v25 offset:4416
    ds_write_b32 v251, v28 offset:6656
    ds_write_b32 v251, v29 offset:6720
    s_mov_b64 exec, -1
    buffer_load_dwordx4 v246, s[8:11], s77 offen lds
    v_mov_b32 v96, 0
    v_mov_b32 v97, 0
    v_mov_b32 v98, 0x3f803f80
    v_add_u32 v99, s69, v248
    s_add_u32 s47, s82, 4096
    s_waitcnt vmcnt(1) lgkmcnt(0)
    s_cmp_lg_u32 s42, 7
    s_cbranch_scc1 L_pollskip_25
    s_add_u32 s44, s37, 2048
    s_mov_b64 exec, 0xffffffff
    s_mov_b32 s45, 200000
L_poll_26:
    buffer_load_dword v4, v3, s[16:19], s44 offen sc0 sc1
    s_sub_u32 s45, s45, 1
    s_cbranch_scc1 L_poll_26_out
    s_waitcnt vmcnt(0)
    v_cmp_ne_u32 vcc, s43, v4
    s_cbranch_vccnz L_poll_26
L_poll_26_out:
    s_waitcnt vmcnt(0)
    s_mov_b64 exec, -1
L_pollskip_25:
    s_barrier
    buffer_load_dwordx4 v[176:179], v2, s[16:19], s82 offen offset:0 sc0 sc1
    buffer_load_dwordx4 v[180:183], v2, s[16:19], s82 offen offset:1024 sc0 sc1
    buffer_load_dwordx4 v[184:187], v2, s[16:19], s82 offen offset:2048 sc0 sc1
    buffer_load_dwordx4 v[188:191], v2, s[16:19], s82 offen offset:3072 sc0 sc1
    buffer_load_dwordx4 v[192:195], v2, s[16:19], s47 offen offset:0 sc0 sc1
    buffer_load_dwordx4 v[196:199], v2, s[16:19], s47 offen offset:1024 sc0 sc1
    buffer_load_dwordx4 v[200:203], v2, s[16:19], s47 offen offset:2048 sc0 sc1
    buffer_load_dwordx4 v[204:207], v2, s[16:19], s47 offen offset:3072 sc0 sc1
    s_cmp_lg_u32 s2, 0
    s_cbranch_scc1 L_nobump
    s_cmp_lg_u32 s42, 7
    s_cbranch_scc1 L_nobump
    s_mov_b32 s44, 0x1108000
    v_mov_b32 v4, s43
    s_mov_b64 exec, 1
    buffer_store_dword v4, v3, s[16:19], s44 offen sc0 sc1
    s_mov_b64 exec, -1
    s_waitcnt vmcnt(0)
L_nobump:
    ds_read_b64_tr_b16 v[208:209], v244 offset:0
    ds_read_b64_tr_b16 v[210:211], v244 offset:1024
    ds_read_b64_tr_b16 v[212:213], v245 offset:0
    ds_read_b64_tr_b16 v[214:215], v245 offset:1024
    ds_read_b64_tr_b16 v[216:217], v244 offset:2304
    ds_read_b64_tr_b16 v[218:219], v244 offset:3328
    ds_read_b64_tr_b16 v[220:221], v245 offset:2304
    ds_read_b64_tr_b16 v[222:223], v245 offset:3328
    ds_read_b64_tr_b16 v[224:225], v244 offset:8192
    ds_read_b64_tr_b16 v[226:227], v244 offset:9216
    ds_read_b64_tr_b16 v[228:229], v245 offset:8192
    ds_read_b64_tr_b16 v[230:231], v245 offset:9216
    ds_read_b64_tr_b16 v[80:81], v244 offset:10496
    ds_read_b64_tr_b16 v[82:83], v244 offset:11520
    ds_read_b64_tr_b16 v[84:85], v245 offset:10496
    ds_read_b64_tr_b16 v[86:87], v245 offset:11520
    s_cmp_ge_u32 s42, 3
    s_cbranch_scc1 L_noc
    s_mul_i32 s44, s42, 2304
    v_lshl_add_u32 v5, v1, 2, s44
    s_mov_b64 exec, 0xffffffff
    ds_read_b32 v48, v5 offset:2048
    ds_read_b32 v49, v5 offset:10240
    ds_read_b32 v50, v5 offset:18432
    ds_read_b32 v51, v5 offset:26624
    ds_read_b32 v52, v5 offset:34816
    ds_read_b32 v53, v5 offset:43008
    ds_read_b32 v54, v5 offset:51200
    ds_read_b32 v55, v5 offset:59392
    s_waitcnt lgkmcnt(0)
    v_pk_add_f32 v[48:49], v[48:49], v[50:51]
    v_pk_add_f32 v[52:53], v[52:53], v[54:55]
    v_pk_add_f32 v[48:49], v[48:49], v[52:53]
    s_nop 0
    v_add_f32 v48, v48, v49
    s_nop 0
    ds_write_b32 v251, v48 offset:7936
    s_mov_b64 exec, -1
L_noc:
    s_waitcnt lgkmcnt(0)
    s_barrier
    s_waitcnt vmcnt(7)
    v_mfma_f32_32x32x16_bf16 v[16:31], v[100:103], v[176:179], 0
    v_mfma_f32_32x32x16_bf16 v[32:47], v[104:107], v[176:179], 0
    s_waitcnt vmcnt(6)
    v_mfma_f32_32x32x16_bf16 v[16:31], v[108:111], v[180:183], v[16:31]
    v_mfma_f32_32x32x16_bf16 v[32:47], v[112:115], v[180:183], v[32:47]
    s_waitcnt vmcnt(5)
    v_mfma_f32_32x32x16_bf16 v[16:31], v[116:119], v[184:187], v[16:31]
    v_mfma_f32_32x32x16_bf16 v[32:47], v[120:123], v[184:187], v[32:47]
    s_waitcnt vmcnt(4)
    v_mfma_f32_32x32x16_bf16 v[16:31], v[124:127], v[188:191], v[16:31]
    v_mfma_f32_32x32x16_bf16 v[32:47], v[128:131], v[188:191], v[32:47]
    s_waitcnt vmcnt(3)
    v_mfma_f32_32x32x16_bf16 v[16:31], v[132:135], v[192:195], v[16:31]
    v_mfma_f32_32x32x16_bf16 v[32:47], v[136:139], v[192:195], v[32:47]
    s_waitcnt vmcnt(2)
    v_mfma_f32_32x32x16_bf16 v[16:31], v[140:143], v[196:199], v[16:31]
    v_mfma_f32_32x32x16_bf16 v[32:47], v[144:147], v[196:199], v[32:47]
    s_waitcnt vmcnt(1)
    v_mfma_f32_32x32x16_bf16 v[16:31], v[148:151], v[200:203], v[16:31]
    v_mfma_f32_32x32x16_bf16 v[32:47], v[152:155], v[200:203], v[32:47]
    s_waitcnt vmcnt(0)
    v_mfma_f32_32x32x16_bf16 v[16:31], v[156:159], v[204:207], v[16:31]
    v_mfma_f32_32x32x16_bf16 v[32:47], v[160:163], v[204:207], v[32:47]
    buffer_load_dwordx4 v[236:239], v2, s[16:19], s79 offen offset:0
    buffer_load_dwordx4 v[236:239], v2, s[16:19], s79 offen offset:1024
    buffer_load_dwordx4 v[236:239], v2, s[16:19], s79 offen offset:2048
    v_xor_b32 v7, 16, v247
    v_and_b32 v5, 31, v1
    v_lshlrev_b32 v5, 2, v5
    s_nop 3
    s_cmp_ge_u32 s73, 2
    s_cbranch_scc1 L_redhi_27
    ds_write_b128 v15, v[24:27] offset:2304
    ds_write_b128 v15, v[28:31] offset:3328
    ds_write_b128 v15, v[32:35] offset:0
    ds_write_b128 v15, v[36:39] offset:1024
    ds_write_b128 v15, v[40:43] offset:4608
    ds_write_b128 v15, v[44:47] offset:5632
    s_branch L_redj_28
L_redhi_27:
    ds_write_b128 v15, v[16:19] offset:2304
    ds_write_b128 v15, v[20:23] offset:3328
    ds_write_b128 v15, v[40:43] offset:0
    ds_write_b128 v15, v[44:47] offset:1024
    ds_write_b128 v15, v[32:35] offset:4608
    ds_write_b128 v15, v[36:39] offset:5632
    v_pk_mul_f32 v[16:17], v[24:25], 1.0 op_sel_hi:[1,0]
    v_pk_mul_f32 v[18:19], v[26:27], 1.0 op_sel_hi:[1,0]
    v_pk_mul_f32 v[20:21], v[28:29], 1.0 op_sel_hi:[1,0]
    v_pk_mul_f32 v[22:23], v[30:31], 1.0 op_sel_hi:[1,0]
L_redj_28:
    s_waitcnt lgkmcnt(0)
    s_barrier
    ds_read_b128 v[56:59], v12
    ds_read_b128 v[60:63], v12 offset:1024
    ds_read_b128 v[64:67], v13
    ds_read_b128 v[68:71], v13 offset:1024
    ds_read_b128 v[72:75], v14
    ds_read_b128 v[76:79], v14 offset:1024
    ds_read_b64 v[52:53], v247
    ds_read_b64 v[54:55], v7
    s_waitcnt lgkmcnt(6)
    v_pk_add_f32 v[16:17], v[16:17], v[56:57]
    v_pk_add_f32 v[18:19], v[18:19], v[58:59]
    v_pk_add_f32 v[20:21], v[20:21], v[60:61]
    v_pk_add_f32 v[22:23], v[22:23], v[62:63]
    s_waitcnt lgkmcnt(2)
    v_pk_add_f32 v[64:65], v[64:65], v[72:73]
    v_pk_add_f32 v[66:67], v[66:67], v[74:75]
    v_pk_add_f32 v[68:69], v[68:69], v[76:77]
    v_pk_add_f32 v[70:71], v[70:71], v[78:79]
    s_waitcnt lgkmcnt(0)
    v_lshlrev_b32 v56, 16, v52
    v_and_b32 v57, 0xffff0000, v52
    v_lshlrev_b32 v58, 16, v53
    v_and_b32 v59, 0xffff0000, v53
    v_lshlrev_b32 v60, 16, v54
    v_and_b32 v61, 0xffff0000, v54
    v_lshlrev_b32 v62, 16, v55
    v_and_b32 v63, 0xffff0000, v55
    v_pk_add_f32 v[16:17], v[16:17], v[64:65]
    v_pk_add_f32 v[18:19], v[18:19], v[66:67]
    v_pk_add_f32 v[20:21], v[20:21], v[68:69]
    v_pk_add_f32 v[22:23], v[22:23], v[70:71]
    v_pk_add_f32 v[16:17], v[16:17], v[56:57]
    v_pk_add_f32 v[18:19], v[18:19], v[58:59]
    v_pk_add_f32 v[20:21], v[20:21], v[60:61]
    v_pk_add_f32 v[22:23], v[22:23], v[62:63]
    v_cvt_pk_bf16_f32 v232, v16, v17
    v_cvt_pk_bf16_f32 v233, v18, v19
    v_cvt_pk_bf16_f32 v234, v20, v21
    v_cvt_pk_bf16_f32 v235, v22, v23
    s_cmp_eq_u32 s3, 0
    s_cbranch_scc1 L_stg_29
    buffer_store_dwordx4 v[232:235], v175, s[32:35], s80 offen
    s_branch L_stj_30
L_stg_29:
    buffer_store_dwordx4 v[232:235], v175, s[32:35], s80 offen sc0 sc1
L_stj_30:
    v_dot2c_f32_bf16 v96, v232, v98
    v_dot2c_f32_bf16 v97, v232, v232
    v_dot2c_f32_bf16 v96, v233, v98
    v_dot2c_f32_bf16 v97, v233, v233
    v_dot2c_f32_bf16 v96, v234, v98
    v_dot2c_f32_bf16 v97, v234, v234
    v_dot2c_f32_bf16 v96, v235, v98
    v_dot2c_f32_bf16 v97, v235, v235
    s_nop 2
    v_permlane32_swap_b32 v96, v97
    s_nop 0
    v_add_f32 v96, v96, v97
    s_cmp_lg_u32 s73, 0
    ds_write_b32 v99, v96 offset:2048
    ds_read_b32 v164, v5 offset:7936
    ds_read_b32 v165, v5 offset:16128
    ds_read_b32 v166, v5 offset:24320
    s_waitcnt lgkmcnt(0)
    s_barrier
    s_cbranch_scc1 L_nost
    ds_read_b32 v56, v99 offset:18432
    ds_read_b32 v57, v99 offset:34816
    ds_read_b32 v58, v99 offset:51200
    s_waitcnt lgkmcnt(0)
    v_add_f32 v96, v96, v56
    v_add_f32 v57, v57, v58
    s_nop 0
    v_add_f32 v96, v96, v57
    s_cmp_eq_u32 s3, 0
    s_cbranch_scc1 L_stg_31
    buffer_store_dword v96, v248, s[16:19], s81 offen
    s_branch L_stj_32
L_stg_31:
    buffer_store_dword v96, v248, s[16:19], s81 offen sc0 sc1
L_stj_32:
L_nost:
    ds_read_b64_tr_b16 v[16:17], v242 offset:0
    ds_read_b64_tr_b16 v[18:19], v242 offset:256
    ds_read_b64_tr_b16 v[20:21], v242 offset:2048
    ds_read_b64_tr_b16 v[22:23], v242 offset:2304
    ds_read_b64_tr_b16 v[24:25], v242 offset:4096
    ds_read_b64_tr_b16 v[26:27], v242 offset:4352
    ds_read_b64_tr_b16 v[28:29], v242 offset:512
    ds_read_b64_tr_b16 v[30:31], v242 offset:768
    ds_read_b64_tr_b16 v[32:33], v242 offset:2560
    ds_read_b64_tr_b16 v[34:35], v242 offset:2816
    ds_read_b64_tr_b16 v[36:37], v242 offset:4608
    ds_read_b64_tr_b16 v[38:39], v242 offset:4864
    s_cmp_lg_u32 s42, 7
    s_cbranch_scc1 L_sig_33
    v_mov_b32 v4, s43
    v_lshlrev_b32 v3, 2, v1
    s_add_u32 s44, s36, 4096
    s_cmp_eq_u32 s3, 0
    s_cbranch_scc1 L_sgl_34
    s_mov_b64 exec, 1
    s_waitcnt vmcnt(0)
    s_barrier
    buffer_store_dword v4, v3, s[16:19], s44 offen
    s_mov_b64 exec, -1
    s_branch L_sig_33_j
L_sgl_34:
    s_mov_b64 exec, 1
    s_waitcnt vmcnt(0)
    s_barrier
    buffer_store_dword v4, v3, s[16:19], s44 offen sc0 sc1
    s_mov_b64 exec, -1
    s_branch L_sig_33_j
L_sig_33:
    s_waitcnt vmcnt(0)
    s_barrier
L_sig_33_j:
    s_add_u32 m0, s68, 0
    s_add_u32 s44, s69, 262144
    buffer_load_dwordx4 v11, s[28:31], s44 offen lds
    s_add_u32 m0, s68, 8192
    s_add_u32 s44, s69, 327680
    buffer_load_dwordx4 v11, s[28:31], s44 offen lds
    s_add_u32 m0, s68, 16384
    s_add_u32 s44, s69, 393216
    buffer_load_dwordx4 v11, s[28:31], s44 offen lds
    s_add_u32 m0, s68, 24576
    s_add_u32 s44, s69, 458752
    buffer_load_dwordx4 v11, s[28:31], s44 offen lds
    s_cmp_lg_u32 s42, 7
    s_cbranch_scc1 L_pollskip_35
    s_add_u32 s44, s37, 4096
    s_mov_b64 exec, 0xffffffff
    s_mov_b32 s45, 200000
L_poll_36:
    buffer_load_dword v4, v3, s[16:19], s44 offen sc0 sc1
    s_sub_u32 s45, s45, 1
    s_cbranch_scc1 L_poll_36_out
    s_waitcnt vmcnt(0)
    v_cmp_ne_u32 vcc, s43, v4
    s_cbranch_vccnz L_poll_36
L_poll_36_out:
    s_waitcnt vmcnt(0)
    s_mov_b64 exec, -1
L_pollskip_35:
    s_barrier
    s_cmp_ge_u32 s41, 29
    s_cbranch_scc1 L_p4_idle
    buffer_load_dwordx4 v[176:179], v175, s[32:35], s54 offen offset:0 sc0 sc1
    buffer_load_dwordx4 v[180:183], v175, s[32:35], s55 offen offset:0 sc0 sc1
    buffer_load_dwordx4 v[184:187], v175, s[32:35], s56 offen offset:0 sc0 sc1
    buffer_load_dwordx4 v[188:191], v175, s[32:35], s57 offen offset:0 sc0 sc1
    v_cmp_gt_u32 vcc, 32, v1
    s_mov_b32 s47, 0x3b000000
    s_nop 0
    v_cndmask_b32 v164, 0, v164, vcc
    v_mov_b32 v70, 0
    v_cvt_pk_bf16_f32 v68, v164, v164
    v_and_b32 v6, 0xffff0000, v68
    v_sub_f32 v6, v164, v6
    v_mov_b32 v71, 0
    v_cvt_pk_bf16_f32 v69, v6, v70
    v_cndmask_b32 v165, 0, v165, vcc
    v_mov_b32 v74, 0
    v_cvt_pk_bf16_f32 v72, v165, v165
    v_and_b32 v6, 0xffff0000, v72
    v_sub_f32 v6, v165, v6
    v_mov_b32 v75, 0
    v_cvt_pk_bf16_f32 v73, v6, v74
    v_cndmask_b32 v166, 0, v166, vcc
    v_mov_b32 v78, 0
    v_cvt_pk_bf16_f32 v76, v166, v166
    v_and_b32 v6, 0xffff0000, v76
    v_sub_f32 v6, v166, v6
    v_mov_b32 v79, 0
    v_cvt_pk_bf16_f32 v77, v6, v78
    s_setprio 3
    s_waitcnt vmcnt(3) lgkmcnt(6)
    v_mfma_f32_32x32x16_bf16 v[112:127], v[16:19], v[176:179], 0
    ds_read_b64_tr_b16 v[100:101], v242 offset:6144
    ds_read_b64_tr_b16 v[102:103], v242 offset:6400
    v_mfma_f32_32x32x16_bf16 v[128:143], v[20:23], v[176:179], 0
    ds_read_b64_tr_b16 v[104:105], v242 offset:8192
    ds_read_b64_tr_b16 v[106:107], v242 offset:8448
    v_mfma_f32_32x32x16_bf16 v[144:159], v[24:27], v[176:179], 0
    ds_read_b64_tr_b16 v[108:109], v242 offset:10240
    ds_read_b64_tr_b16 v[110:111], v242 offset:10496
    buffer_load_dwordx4 v[176:179], v175, s[32:35], s54 offen offset:128 sc0 sc1
    s_waitcnt vmcnt(3) lgkmcnt(6)
    v_mfma_f32_32x32x16_bf16 v[112:127], v[28:31], v[180:183], v[112:127]
    ds_read_b64_tr_b16 v[16:17], v242 offset:6656
    ds_read_b64_tr_b16 v[18:19], v242 offset:6912
    v_mfma_f32_32x32x16_bf16 v[128:143], v[32:35], v[180:183], v[128:143]
    ds_read_b64_tr_b16 v[20:21], v242 offset:8704
    ds_read_b64_tr_b16 v[22:23], v242 offset:8960
    v_mfma_f32_32x32x16_bf16 v[144:159], v[36:39], v[180:183], v[144:159]
    ds_read_b64_tr_b16 v[24:25], v242 offset:10752
    ds_read_b64_tr_b16 v[26:27], v242 offset:11008
    buffer_load_dwordx4 v[180:183], v175, s[32:35], s55 offen offset:128 sc0 sc1
    s_waitcnt vmcnt(3) lgkmcnt(6)
    v_mfma_f32_32x32x16_bf16 v[112:127], v[100:103], v[184:187], v[112:127]
    ds_read_b64_tr_b16 v[28:29], v242 offset:12288
    ds_read_b64_tr_b16 v[30:31], v242 offset:12544
    v_mfma_f32_32x32x16_bf16 v[128:143], v[104:107], v[184:187], v[128:143]
    ds_read_b64_tr_b16 v[32:33], v242 offset:14336
    ds_read_b64_tr_b16 v[34:35], v242 offset:14592
    v_mfma_f32_32x32x16_bf16 v[144:159], v[108:111], v[184:187], v[144:159]
    ds_read_b64_tr_b16 v[36:37], v242 offset:16384
    ds_read_b64_tr_b16 v[38:39], v242 offset:16640
    buffer_load_dwordx4 v[184:187], v175, s[32:35], s56 offen offset:128 sc0 sc1
    buffer_load_dwordx2 v[44:45], v250, s[16:19], s84 offen offset:0 sc0 sc1
    s_waitcnt vmcnt(4) lgkmcnt(6)
    v_mfma_f32_32x32x16_bf16 v[112:127], v[16:19], v[188:191], v[112:127]
    ds_read_b64_tr_b16 v[100:101], v242 offset:12800
    ds_read_b64_tr_b16 v[102:103], v242 offset:13056
    v_mfma_f32_32x32x16_bf16 v[128:143], v[20:23], v[188:191], v[128:143]
    ds_read_b64_tr_b16 v[104:105], v242 offset:14848
    ds_read_b64_tr_b16 v[106:107], v242 offset:15104
    v_mfma_f32_32x32x16_bf16 v[144:159], v[24:27], v[188:191], v[144:159]
    ds_read_b64_tr_b16 v[108:109], v242 offset:16896
    ds_read_b64_tr_b16 v[110:111], v242 offset:17152
    buffer_load_dwordx4 v[188:191], v175, s[32:35], s57 offen offset:128 sc0 sc1
    buffer_load_dwordx2 v[46:47], v250, s[16:19], s84 offen offset:256 sc0 sc1
    s_waitcnt vmcnt(5) lgkmcnt(6)
    v_mfma_f32_32x32x16_bf16 v[112:127], v[28:31], v[176:179], v[112:127]
    ds_read_b64_tr_b16 v[16:17], v242 offset:18432
    ds_read_b64_tr_b16 v[18:19], v242 offset:18688
    v_mfma_f32_32x32x16_bf16 v[128:143], v[32:35], v[176:179], v[128:143]
    ds_read_b64_tr_b16 v[20:21], v242 offset:20480
    ds_read_b64_tr_b16 v[22:23], v242 offset:20736
    v_mfma_f32_32x32x16_bf16 v[144:159], v[36:39], v[176:179], v[144:159]
    ds_read_b64_tr_b16 v[24:25], v242 offset:22528
    ds_read_b64_tr_b16 v[26:27], v242 offset:22784
    buffer_load_dwordx4 v[176:179], v175, s[32:35], s54 offen offset:256 sc0 sc1
    buffer_load_dwordx2 v[48:49], v250, s[16:19], s84 offen offset:512 sc0 sc1
    s_waitcnt vmcnt(6) lgkmcnt(6)
    v_mfma_f32_32x32x16_bf16 v[112:127], v[100:103], v[180:183], v[112:127]
    ds_read_b64_tr_b16 v[28:29], v242 offset:18944
    ds_read_b64_tr_b16 v[30:31], v242 offset:19200
    v_mfma_f32_32x32x16_bf16 v[128:143], v[104:107], v[180:183], v[128:143]
    ds_read_b64_tr_b16 v[32:33], v242 offset:20992
    ds_read_b64_tr_b16 v[34:35], v242 offset:21248
    v_mfma_f32_32x32x16_bf16 v[144:159], v[108:111], v[180:183], v[144:159]
    ds_read_b64_tr_b16 v[36:37], v242 offset:23040
    ds_read_b64_tr_b16 v[38:39], v242 offset:23296
    buffer_load_dwordx4 v[180:183], v175, s[32:35], s55 offen offset:256 sc0 sc1
    buffer_load_dwordx2 v[50:51], v250, s[16:19], s84 offen offset:768 sc0 sc1
    s_waitcnt vmcnt(7) lgkmcnt(6)
    v_mfma_f32_32x32x16_bf16 v[112:127], v[16:19], v[184:187], v[112:127]
    ds_read_b64_tr_b16 v[100:101], v242 offset:24576
    ds_read_b64_tr_b16 v[102:103], v242 offset:24832
    v_mfma_f32_32x32x16_bf16 v[128:143], v[20:23], v[184:187], v[128:143]
    ds_read_b64_tr_b16 v[104:105], v242 offset:26624
    ds_read_b64_tr_b16 v[106:107], v242 offset:26880
    v_mfma_f32_32x32x16_bf16 v[144:159], v[24:27], v[184:187], v[144:159]
    ds_read_b64_tr_b16 v[108:109], v242 offset:28672
    ds_read_b64_tr_b16 v[110:111], v242 offset:28928
    buffer_load_dwordx4 v[184:187], v175, s[32:35], s56 offen offset:256 sc0 sc1
    s_waitcnt vmcnt(6) lgkmcnt(6)
    v_mfma_f32_32x32x16_bf16 v[112:127], v[28:31], v[188:191], v[112:127]
    ds_read_b64_tr_b16 v[16:17], v242 offset:25088
    ds_read_b64_tr_b16 v[18:19], v242 offset:25344
    v_mfma_f32_32x32x16_bf16 v[128:143], v[32:35], v[188:191], v[128:143]
    ds_read_b64_tr_b16 v[20:21], v242 offset:27136
    ds_read_b64_tr_b16 v[22:23], v242 offset:27392
    v_mfma_f32_32x32x16_bf16 v[144:159], v[36:39], v[188:191], v[144:159]
    ds_read_b64_tr_b16 v[24:25], v242 offset:29184
    ds_read_b64_tr_b16 v[26:27], v242 offset:29440
    buffer_load_dwordx4 v[188:191], v175, s[32:35], s57 offen offset:256 sc0 sc1
    s_waitcnt vmcnt(5) lgkmcnt(6)
    v_mfma_f32_32x32x16_bf16 v[112:127], v[100:103], v[176:179], v[112:127]
    ds_read_b64_tr_b16 v[28:29], v242 offset:30720
    ds_read_b64_tr_b16 v[30:31], v242 offset:30976
    v_mfma_f32_32x32x16_bf16 v[128:143], v[104:107], v[176:179], v[128:143]
    ds_read_b64_tr_b16 v[32:33], v242 offset:32768
    ds_read_b64_tr_b16 v[34:35], v242 offset:33024
    v_mfma_f32_32x32x16_bf16 v[144:159], v[108:111], v[176:179], v[144:159]
    ds_read_b64_tr_b16 v[36:37], v242 offset:34816
    ds_read_b64_tr_b16 v[38:39], v242 offset:35072
    buffer_load_dwordx4 v[176:179], v175, s[32:35], s54 offen offset:384 sc0 sc1
    s_add_u32 m0, s68, 32768
    s_add_u32 s44, s69, 524288
    buffer_load_dwordx4 v11, s[28:31], s44 offen lds
    s_waitcnt vmcnt(5) lgkmcnt(6)
    v_mfma_f32_32x32x16_bf16 v[112:127], v[16:19], v[180:183], v[112:127]
    ds_read_b64_tr_b16 v[100:101], v242 offset:31232
    ds_read_b64_tr_b16 v[102:103], v242 offset:31488
    v_mfma_f32_32x32x16_bf16 v[128:143], v[20:23], v[180:183], v[128:143]
    ds_read_b64_tr_b16 v[104:105], v242 offset:33280
    ds_read_b64_tr_b16 v[106:107], v242 offset:33536
    v_mfma_f32_32x32x16_bf16 v[144:159], v[24:27], v[180:183], v[144:159]
    ds_read_b64_tr_b16 v[108:109], v242 offset:35328
    ds_read_b64_tr_b16 v[110:111], v242 offset:35584
    buffer_load_dwordx4 v[180:183], v175, s[32:35], s55 offen offset:384 sc0 sc1
    s_waitcnt vmcnt(4) lgkmcnt(6)
    v_mfma_f32_32x32x16_bf16 v[112:127], v[28:31], v[184:187], v[112:127]
    ds_read_b64_tr_b16 v[16:17], v242 offset:36864
    ds_read_b64_tr_b16 v[18:19], v242 offset:37120
    v_mfma_f32_32x32x16_bf16 v[128:143], v[32:35], v[184:187], v[128:143]
    ds_read_b64_tr_b16 v[20:21], v242 offset:38912
    ds_read_b64_tr_b16 v[22:23], v242 offset:39168
    v_mfma_f32_32x32x16_bf16 v[144:159], v[36:39], v[184:187], v[144:159]
    ds_read_b64_tr_b16 v[24:25], v242 offset:40960
    ds_read_b64_tr_b16 v[26:27], v242 offset:41216
    buffer_load_dwordx4 v[184:187], v175, s[32:35], s56 offen offset:384 sc0 sc1
    s_add_u32 m0, s68, 40960
    s_add_u32 s44, s69, 589824
    buffer_load_dwordx4 v11, s[28:31], s44 offen lds
    s_waitcnt vmcnt(5) lgkmcnt(6)
    v_mfma_f32_32x32x16_bf16 v[112:127], v[100:103], v[188:191], v[112:127]
    ds_read_b64_tr_b16 v[28:29], v242 offset:37376
    ds_read_b64_tr_b16 v[30:31], v242 offset:37632
    v_mfma_f32_32x32x16_bf16 v[128:143], v[104:107], v[188:191], v[128:143]
    ds_read_b64_tr_b16 v[32:33], v242 offset:39424
    ds_read_b64_tr_b16 v[34:35], v242 offset:39680
    v_mfma_f32_32x32x16_bf16 v[144:159], v[108:111], v[188:191], v[144:159]
    ds_read_b64_tr_b16 v[36:37], v242 offset:41472
    ds_read_b64_tr_b16 v[38:39], v242 offset:41728
    buffer_load_dwordx4 v[188:191], v175, s[32:35], s57 offen offset:384 sc0 sc1
    s_waitcnt vmcnt(5) lgkmcnt(6)
    v_mfma_f32_32x32x16_bf16 v[112:127], v[16:19], v[176:179], v[112:127]
    ds_read_b64_tr_b16 v[100:101], v242 offset:43008
    ds_read_b64_tr_b16 v[102:103], v242 offset:43264
    v_mfma_f32_32x32x16_bf16 v[128:143], v[20:23], v[176:179], v[128:143]
    ds_read_b64_tr_b16 v[104:105], v242 offset:45056
    ds_read_b64_tr_b16 v[106:107], v242 offset:45312
    v_mfma_f32_32x32x16_bf16 v[144:159], v[24:27], v[176:179], v[144:159]
    ds_read_b64_tr_b16 v[108:109], v242 offset:47104
    ds_read_b64_tr_b16 v[110:111], v242 offset:47360
    buffer_load_dwordx4 v[176:179], v175, s[32:35], s54 offen offset:512 sc0 sc1
    s_add_u32 m0, s68, 49152
    s_add_u32 s44, s69, 655360
    buffer_load_dwordx4 v11, s[28:31], s44 offen lds
    s_waitcnt vmcnt(5) lgkmcnt(6)
    v_mfma_f32_32x32x16_bf16 v[112:127], v[28:31], v[180:183], v[112:127]
    ds_read_b64_tr_b16 v[16:17], v242 offset:43520
    ds_read_b64_tr_b16 v[18:19], v242 offset:43776
    v_mfma_f32_32x32x16_bf16 v[128:143], v[32:35], v[180:183], v[128:143]
    ds_read_b64_tr_b16 v[20:21], v242 offset:45568
    ds_read_b64_tr_b16 v[22:23], v242 offset:45824
    v_mfma_f32_32x32x16_bf16 v[144:159], v[36:39], v[180:183], v[144:159]
    ds_read_b64_tr_b16 v[24:25], v242 offset:47616
    ds_read_b64_tr_b16 v[26:27], v242 offset:47872
    buffer_load_dwordx4 v[180:183], v175, s[32:35], s55 offen offset:512 sc0 sc1
    s_setprio 2
    s_waitcnt vmcnt(5) lgkmcnt(6)
    v_mfma_f32_32x32x16_bf16 v[112:127], v[100:103], v[184:187], v[112:127]
    ds_read_b64_tr_b16 v[28:29], v243 offset:0
    ds_read_b64_tr_b16 v[30:31], v243 offset:256
    v_mfma_f32_32x32x16_bf16 v[128:143], v[104:107], v[184:187], v[128:143]
    ds_read_b64_tr_b16 v[32:33], v243 offset:2048
    ds_read_b64_tr_b16 v[34:35], v243 offset:2304
    v_mfma_f32_32x32x16_bf16 v[144:159], v[108:111], v[184:187], v[144:159]
    ds_read_b64_tr_b16 v[36:37], v243 offset:4096
    ds_read_b64_tr_b16 v[38:39], v243 offset:4352
    buffer_load_dwordx4 v[184:187], v175, s[32:35], s56 offen offset:512 sc0 sc1
    s_add_u32 m0, s68, 57344
    s_add_u32 s44, s69, 720896
    buffer_load_dwordx4 v11, s[28:31], s44 offen lds
    s_waitcnt vmcnt(5) lgkmcnt(6)
    v_mfma_f32_32x32x16_bf16 v[112:127], v[16:19], v[188:191], v[112:127]
    ds_read_b64_tr_b16 v[100:101], v243 offset:512
    ds_read_b64_tr_b16 v[102:103], v243 offset:768
    v_mfma_f32_32x32x16_bf16 v[128:143], v[20:23], v[188:191], v[128:143]
    ds_read_b64_tr_b16 v[104:105], v243 offset:2560
    ds_read_b64_tr_b16 v[106:107], v243 offset:2816
    v_mfma_f32_32x32x16_bf16 v[144:159], v[24:27], v[188:191], v[144:159]
    ds_read_b64_tr_b16 v[108:109], v243 offset:4608
    ds_read_b64_tr_b16 v[110:111], v243 offset:4864
    buffer_load_dwordx4 v[188:191], v175, s[32:35], s57 offen offset:512 sc0 sc1
    s_waitcnt vmcnt(5) lgkmcnt(6)
    v_mfma_f32_32x32x16_bf16 v[112:127], v[28:31], v[176:179], v[112:127]
    ds_read_b64_tr_b16 v[16:17], v243 offset:6144
    ds_read_b64_tr_b16 v[18:19], v243 offset:6400
    v_mfma_f32_32x32x16_bf16 v[128:143], v[32:35], v[176:179], v[128:143]
    ds_read_b64_tr_b16 v[20:21], v243 offset:8192
    ds_read_b64_tr_b16 v[22:23], v243 offset:8448
    v_mfma_f32_32x32x16_bf16 v[144:159], v[36:39], v[176:179], v[144:159]
    ds_read_b64_tr_b16 v[24:25], v243 offset:10240
    ds_read_b64_tr_b16 v[26:27], v243 offset:10496
    buffer_load_dwordx4 v[176:179], v175, s[32:35], s54 offen offset:640 sc0 sc1
    v_add_f32 v44, v44, v46
    v_add_f32 v45, v45, v47
    v_add_f32 v44, v44, v48
    s_waitcnt vmcnt(4) lgkmcnt(6)
    s_barrier
    v_mfma_f32_32x32x16_bf16 v[112:127], v[100:103], v[180:183], v[112:127]
    ds_read_b64_tr_b16 v[28:29], v243 offset:6656
    ds_read_b64_tr_b16 v[30:31], v243 offset:6912
    v_mfma_f32_32x32x16_bf16 v[128:143], v[104:107], v[180:183], v[128:143]
    ds_read_b64_tr_b16 v[32:33], v243 offset:8704
    ds_read_b64_tr_b16 v[34:35], v243 offset:8960
    v_mfma_f32_32x32x16_bf16 v[144:159], v[108:111], v[180:183], v[144:159]
    ds_read_b64_tr_b16 v[36:37], v243 offset:10752
    ds_read_b64_tr_b16 v[38:39], v243 offset:11008
    buffer_load_dwordx4 v[180:183], v175, s[32:35], s55 offen offset:640 sc0 sc1
    v_add_f32 v45, v45, v49
    v_add_f32 v44, v44, v50
    v_add_f32 v45, v45, v51
    s_waitcnt vmcnt(4) lgkmcnt(6)
    v_mfma_f32_32x32x16_bf16 v[112:127], v[16:19], v[184:187], v[112:127]
    ds_read_b64_tr_b16 v[100:101], v243 offset:12288
    ds_read_b64_tr_b16 v[102:103], v243 offset:12544
    v_mfma_f32_32x32x16_bf16 v[128:143], v[20:23], v[184:187], v[128:143]
    ds_read_b64_tr_b16 v[104:105], v243 offset:14336
    ds_read_b64_tr_b16 v[106:107], v243 offset:14592
    v_mfma_f32_32x32x16_bf16 v[144:159], v[24:27], v[184:187], v[144:159]
    ds_read_b64_tr_b16 v[108:109], v243 offset:16384
    ds_read_b64_tr_b16 v[110:111], v243 offset:16640
    buffer_load_dwordx4 v[184:187], v175, s[32:35], s56 offen offset:640 sc0 sc1
    v_mov_b32 v46, v44
    v_mov_b32 v47, v45
    s_nop 0
    s_waitcnt vmcnt(3) lgkmcnt(6)
    v_mfma_f32_32x32x16_bf16 v[112:127], v[28:31], v[188:191], v[112:127]
    ds_read_b64_tr_b16 v[16:17], v243 offset:12800
    ds_read_b64_tr_b16 v[18:19], v243 offset:13056
    v_mfma_f32_32x32x16_bf16 v[128:143], v[32:35], v[188:191], v[128:143]
    ds_read_b64_tr_b16 v[20:21], v243 offset:14848
    ds_read_b64_tr_b16 v[22:23], v243 offset:15104
    v_mfma_f32_32x32x16_bf16 v[144:159], v[36:39], v[188:191], v[144:159]
    ds_read_b64_tr_b16 v[24:25], v243 offset:16896
    ds_read_b64_tr_b16 v[26:27], v243 offset:17152
    buffer_load_dwordx4 v[188:191], v175, s[32:35], s57 offen offset:640 sc0 sc1
    v_permlane32_swap_b32 v44, v46
    v_permlane32_swap_b32 v45, v47
    s_nop 0
    s_waitcnt vmcnt(3) lgkmcnt(6)
    v_mfma_f32_32x32x16_bf16 v[112:127], v[100:103], v[176:179], v[112:127]
    ds_read_b64_tr_b16 v[28:29], v243 offset:18432
    ds_read_b64_tr_b16 v[30:31], v243 offset:18688
    v_mfma_f32_32x32x16_bf16 v[128:143], v[104:107], v[176:179], v[128:143]
    ds_read_b64_tr_b16 v[32:33], v243 offset:20480
    ds_read_b64_tr_b16 v[34:35], v243 offset:20736
    v_mfma_f32_32x32x16_bf16 v[144:159], v[108:111], v[176:179], v[144:159]
    ds_read_b64_tr_b16 v[36:37], v243 offset:22528
    ds_read_b64_tr_b16 v[38:39], v243 offset:22784
    buffer_load_dwordx4 v[176:179], v175, s[32:35], s54 offen offset:768 sc0 sc1
    s_add_u32 m0, s68, 65536
    s_add_u32 s44, s69, 786432
    buffer_load_dwordx4 v11, s[28:31], s44 offen lds
    v_add_f32 v44, v44, v46
    v_add_f32 v45, v45, v47
    v_mul_f32 v44, s47, v44
    s_waitcnt vmcnt(4) lgkmcnt(6)
    v_mfma_f32_32x32x16_bf16 v[112:127], v[16:19], v[180:183], v[112:127]
    ds_read_b64_tr_b16 v[100:101], v243 offset:18944
    ds_read_b64_tr_b16 v[102:103], v243 offset:19200
    v_mfma_f32_32x32x16_bf16 v[128:143], v[20:23], v[180:183], v[128:143]
    ds_read_b64_tr_b16 v[104:105], v243 offset:20992
    ds_read_b64_tr_b16 v[106:107], v243 offset:21248
    v_mfma_f32_32x32x16_bf16 v[144:159], v[24:27], v[180:183], v[144:159]
    ds_read_b64_tr_b16 v[108:109], v243 offset:23040
    ds_read_b64_tr_b16 v[110:111], v243 offset:23296
    buffer_load_dwordx4 v[180:183], v175, s[32:35], s55 offen offset:768 sc0 sc1
    s_add_u32 m0, s68, 73728
    s_add_u32 s44, s69, 851968
    buffer_load_dwordx4 v11, s[28:31], s44 offen lds
    v_mul_f32 v96, s47, v45
    v_fma_f32 v96, -v44, v44, v96
    v_max_f32 v96, 0, v96
    s_waitcnt vmcnt(5) lgkmcnt(6)
    v_mfma_f32_32x32x16_bf16 v[112:127], v[28:31], v[184:187], v[112:127]
    ds_read_b64_tr_b16 v[16:17], v243 offset:24576
    ds_read_b64_tr_b16 v[18:19], v243 offset:24832
    v_mfma_f32_32x32x16_bf16 v[128:143], v[32:35], v[184:187], v[128:143]
    ds_read_b64_tr_b16 v[20:21], v243 offset:26624
    ds_read_b64_tr_b16 v[22:23], v243 offset:26880
    v_mfma_f32_32x32x16_bf16 v[144:159], v[36:39], v[184:187], v[144:159]
    ds_read_b64_tr_b16 v[24:25], v243 offset:28672
    ds_read_b64_tr_b16 v[26:27], v243 offset:28928
    buffer_load_dwordx4 v[184:187], v175, s[32:35], s56 offen offset:768 sc0 sc1
    s_add_u32 m0, s68, 81920
    s_add_u32 s44, s69, 917504
    buffer_load_dwordx4 v11, s[28:31], s44 offen lds
    v_add_f32 v96, 0x3727c5ac, v96
    v_rcp_f32 v96, v96
    v_mov_b32 v42, 0
    s_waitcnt vmcnt(6) lgkmcnt(6)
    v_mfma_f32_32x32x16_bf16 v[112:127], v[100:103], v[188:191], v[112:127]
    ds_read_b64_tr_b16 v[28:29], v243 offset:25088
    ds_read_b64_tr_b16 v[30:31], v243 offset:25344
    v_mfma_f32_32x32x16_bf16 v[128:143], v[104:107], v[188:191], v[128:143]
    ds_read_b64_tr_b16 v[32:33], v243 offset:27136
    ds_read_b64_tr_b16 v[34:35], v243 offset:27392
    v_mfma_f32_32x32x16_bf16 v[144:159], v[108:111], v[188:191], v[144:159]
    ds_read_b64_tr_b16 v[36:37], v243 offset:29184
    ds_read_b64_tr_b16 v[38:39], v243 offset:29440
    buffer_load_dwordx4 v[188:191], v175, s[32:35], s57 offen offset:768 sc0 sc1
    s_add_u32 m0, s68, 90112
    s_add_u32 s44, s69, 983040
    buffer_load_dwordx4 v11, s[28:31], s44 offen lds
    v_cndmask_b32 v44, 0, -v44, vcc
    v_cvt_pk_bf16_f32 v41, v44, v42
    v_mov_b32 v43, 0
    s_setprio 1
    s_waitcnt vmcnt(7) lgkmcnt(6)
    v_mfma_f32_32x32x16_bf16 v[112:127], v[16:19], v[176:179], v[112:127]
    ds_read_b64_tr_b16 v[100:101], v243 offset:30720
    ds_read_b64_tr_b16 v[102:103], v243 offset:30976
    v_mfma_f32_32x32x16_bf16 v[128:143], v[20:23], v[176:179], v[128:143]
    ds_read_b64_tr_b16 v[104:105], v243 offset:32768
    ds_read_b64_tr_b16 v[106:107], v243 offset:33024
    v_mfma_f32_32x32x16_bf16 v[144:159], v[24:27], v[176:179], v[144:159]
    ds_read_b64_tr_b16 v[108:109], v243 offset:34816
    ds_read_b64_tr_b16 v[110:111], v243 offset:35072
    buffer_load_dwordx4 v[176:179], v175, s[32:35], s54 offen offset:896 sc0 sc1
    s_add_u32 m0, s68, 98304
    s_add_u32 s44, s69, 1048576
    buffer_load_dwordx4 v11, s[28:31], s44 offen lds
    v_lshlrev_b32 v45, 16, v41
    v_sub_f32 v45, v44, v45
    v_cvt_pk_bf16_f32 v40, v44, v45
    s_waitcnt vmcnt(7) lgkmcnt(6)
    s_barrier
    v_mfma_f32_32x32x16_bf16 v[112:127], v[28:31], v[180:183], v[112:127]
    ds_read_b64_tr_b16 v[16:17], v243 offset:31232
    ds_read_b64_tr_b16 v[18:19], v243 offset:31488
    v_mfma_f32_32x32x16_bf16 v[128:143], v[32:35], v[180:183], v[128:143]
    ds_read_b64_tr_b16 v[20:21], v243 offset:33280
    ds_read_b64_tr_b16 v[22:23], v243 offset:33536
    v_mfma_f32_32x32x16_bf16 v[144:159], v[36:39], v[180:183], v[144:159]
    ds_read_b64_tr_b16 v[24:25], v243 offset:35328
    ds_read_b64_tr_b16 v[26:27], v243 offset:35584
    buffer_load_dwordx4 v[180:183], v175, s[32:35], s55 offen offset:896 sc0 sc1
    s_add_u32 m0, s68, 106496
    s_add_u32 s44, s69, 1114112
    buffer_load_dwordx4 v11, s[28:31], s44 offen lds
    s_waitcnt vmcnt(7) lgkmcnt(6)
    v_mfma_f32_32x32x16_bf16 v[112:127], v[100:103], v[184:187], v[112:127]
    ds_read_b64_tr_b16 v[28:29], v243 offset:36864
    ds_read_b64_tr_b16 v[30:31], v243 offset:37120
    v_mfma_f32_32x32x16_bf16 v[128:143], v[104:107], v[184:187], v[128:143]
    ds_read_b64_tr_b16 v[32:33], v243 offset:38912
    ds_read_b64_tr_b16 v[34:35], v243 offset:39168
    v_mfma_f32_32x32x16_bf16 v[144:159], v[108:111], v[184:187], v[144:159]
    ds_read_b64_tr_b16 v[36:37], v243 offset:40960
    ds_read_b64_tr_b16 v[38:39], v243 offset:41216
    buffer_load_dwordx4 v[184:187], v175, s[32:35], s56 offen offset:896 sc0 sc1
    s_waitcnt vmcnt(6) lgkmcnt(6)
    v_mfma_f32_32x32x16_bf16 v[112:127], v[16:19], v[188:191], v[112:127]
    ds_read_b64_tr_b16 v[100:101], v243 offset:37376
    ds_read_b64_tr_b16 v[102:103], v243 offset:37632
    v_mfma_f32_32x32x16_bf16 v[128:143], v[20:23], v[188:191], v[128:143]
    ds_read_b64_tr_b16 v[104:105], v243 offset:39424
    ds_read_b64_tr_b16 v[106:107], v243 offset:39680
    v_mfma_f32_32x32x16_bf16 v[144:159], v[24:27], v[188:191], v[144:159]
    ds_read_b64_tr_b16 v[108:109], v243 offset:41472
    ds_read_b64_tr_b16 v[110:111], v243 offset:41728
    buffer_load_dwordx4 v[188:191], v175, s[32:35], s57 offen offset:896 sc0 sc1
    s_waitcnt vmcnt(5) lgkmcnt(6)
    v_mfma_f32_32x32x16_bf16 v[112:127], v[28:31], v[176:179], v[112:127]
    ds_read_b64_tr_b16 v[16:17], v243 offset:43008
    ds_read_b64_tr_b16 v[18:19], v243 offset:43264
    v_mfma_f32_32x32x16_bf16 v[128:143], v[32:35], v[176:179], v[128:143]
    ds_read_b64_tr_b16 v[20:21], v243 offset:45056
    ds_read_b64_tr_b16 v[22:23], v243 offset:45312
    v_mfma_f32_32x32x16_bf16 v[144:159], v[36:39], v[176:179], v[144:159]
    ds_read_b64_tr_b16 v[24:25], v243 offset:47104
    ds_read_b64_tr_b16 v[26:27], v243 offset:47360
    s_add_u32 m0, s68, 114688
    s_add_u32 s44, s69, 1179648
    buffer_load_dwordx4 v11, s[28:31], s44 offen lds
    v_mfma_f32_32x32x16_bf16 v[112:127], v[68:71], v[40:43], v[112:127]
    v_mfma_f32_32x32x16_bf16 v[128:143], v[72:75], v[40:43], v[128:143]
    v_mfma_f32_32x32x16_bf16 v[144:159], v[76:79], v[40:43], v[144:159]
    s_waitcnt vmcnt(4) lgkmcnt(6)
    v_mfma_f32_32x32x16_bf16 v[112:127], v[100:103], v[180:183], v[112:127]
    ds_read_b64_tr_b16 v[28:29], v243 offset:43520
    ds_read_b64_tr_b16 v[30:31], v243 offset:43776
    v_mfma_f32_32x32x16_bf16 v[128:143], v[104:107], v[180:183], v[128:143]
    ds_read_b64_tr_b16 v[32:33], v243 offset:45568
    ds_read_b64_tr_b16 v[34:35], v243 offset:45824
    v_mfma_f32_32x32x16_bf16 v[144:159], v[108:111], v[180:183], v[144:159]
    ds_read_b64_tr_b16 v[36:37], v243 offset:47616
    ds_read_b64_tr_b16 v[38:39], v243 offset:47872
    s_add_u32 m0, s68, 122880
    s_add_u32 s44, s69, 1245184
    buffer_load_dwordx4 v11, s[28:31], s44 offen lds
    s_setprio 0
    s_waitcnt vmcnt(3) lgkmcnt(6)
    v_mfma_f32_32x32x16_bf16 v[112:127], v[16:19], v[184:187], v[112:127]
    v_mfma_f32_32x32x16_bf16 v[128:143], v[20:23], v[184:187], v[128:143]
    v_mfma_f32_32x32x16_bf16 v[144:159], v[24:27], v[184:187], v[144:159]
    s_add_u32 m0, s68, 131072
    s_add_u32 s44, s69, 1310720
    buffer_load_dwordx4 v11, s[28:31], s44 offen lds
    s_waitcnt vmcnt(3) lgkmcnt(0)
    v_mfma_f32_32x32x16_bf16 v[112:127], v[28:31], v[188:191], v[112:127]
    v_mfma_f32_32x32x16_bf16 v[128:143], v[32:35], v[188:191], v[128:143]
    v_mfma_f32_32x32x16_bf16 v[144:159], v[36:39], v[188:191], v[144:159]
    s_nop 7
    s_nop 1
    v_max_f32 v112, 0, v112
    v_max_f32 v113, 0, v113
    v_max_f32 v114, 0, v114
    v_max_f32 v115, 0, v115
    v_max_f32 v116, 0, v116
    v_max_f32 v117, 0, v117
    v_max_f32 v118, 0, v118
    v_max_f32 v119, 0, v119
    v_pk_mul_f32 v[120:121], v[120:121], v[96:97] op_sel_hi:[1,0]
    v_pk_mul_f32 v[122:123], v[122:123], v[96:97] op_sel_hi:[1,0]
    v_pk_mul_f32 v[124:125], v[124:125], v[96:97] op_sel_hi:[1,0]
    v_pk_mul_f32 v[126:127], v[126:127], v[96:97] op_sel_hi:[1,0]
    v_pk_mul_f32 v[112:113], v[112:113], v[120:121]
    v_pk_mul_f32 v[114:115], v[114:115], v[122:123]
    v_pk_mul_f32 v[116:117], v[116:117], v[124:125]
    v_pk_mul_f32 v[118:119], v[118:119], v[126:127]
    v_cvt_pk_bf16_f32 v16, v112, v113
    v_cvt_pk_bf16_f32 v17, v114, v115
    v_cvt_pk_bf16_f32 v18, v116, v117
    v_cvt_pk_bf16_f32 v19, v118, v119
    s_cmp_eq_u32 s3, 0
    s_cbranch_scc1 L_stg_37
    buffer_store_dwordx4 v[16:19], v2, s[16:19], s79 offen offset:0
    s_branch L_stj_38
L_stg_37:
    buffer_store_dwordx4 v[16:19], v2, s[16:19], s79 offen offset:0 sc0 sc1
L_stj_38:
    v_max_f32 v128, 0, v128
    v_max_f32 v129, 0, v129
    v_max_f32 v130, 0, v130
    v_max_f32 v131, 0, v131
    v_max_f32 v132, 0, v132
    v_max_f32 v133, 0, v133
    v_max_f32 v134, 0, v134
    v_max_f32 v135, 0, v135
    v_pk_mul_f32 v[136:137], v[136:137], v[96:97] op_sel_hi:[1,0]
    v_pk_mul_f32 v[138:139], v[138:139], v[96:97] op_sel_hi:[1,0]
    v_pk_mul_f32 v[140:141], v[140:141], v[96:97] op_sel_hi:[1,0]
    v_pk_mul_f32 v[142:143], v[142:143], v[96:97] op_sel_hi:[1,0]
    v_pk_mul_f32 v[128:129], v[128:129], v[136:137]
    v_pk_mul_f32 v[130:131], v[130:131], v[138:139]
    v_pk_mul_f32 v[132:133], v[132:133], v[140:141]
    v_pk_mul_f32 v[134:135], v[134:135], v[142:143]
    v_cvt_pk_bf16_f32 v20, v128, v129
    v_cvt_pk_bf16_f32 v21, v130, v131
    v_cvt_pk_bf16_f32 v22, v132, v133
    v_cvt_pk_bf16_f32 v23, v134, v135
    s_cmp_eq_u32 s3, 0
    s_cbranch_scc1 L_stg_39
    buffer_store_dwordx4 v[20:23], v2, s[16:19], s79 offen offset:1024
    s_branch L_stj_40
L_stg_39:
    buffer_store_dwordx4 v[20:23], v2, s[16:19], s79 offen offset:1024 sc0 sc1
L_stj_40:
    v_max_f32 v144, 0, v144
    v_max_f32 v145, 0, v145
    v_max_f32 v146, 0, v146
    v_max_f32 v147, 0, v147
    v_max_f32 v148, 0, v148
    v_max_f32 v149, 0, v149
    v_max_f32 v150, 0, v150
    v_max_f32 v151, 0, v151
    v_pk_mul_f32 v[152:153], v[152:153], v[96:97] op_sel_hi:[1,0]
    v_pk_mul_f32 v[154:155], v[154:155], v[96:97] op_sel_hi:[1,0]
    v_pk_mul_f32 v[156:157], v[156:157], v[96:97] op_sel_hi:[1,0]
    v_pk_mul_f32 v[158:159], v[158:159], v[96:97] op_sel_hi:[1,0]
    v_pk_mul_f32 v[144:145], v[144:145], v[152:153]
    v_pk_mul_f32 v[146:147], v[146:147], v[154:155]
    v_pk_mul_f32 v[148:149], v[148:149], v[156:157]
    v_pk_mul_f32 v[150:151], v[150:151], v[158:159]
    v_cvt_pk_bf16_f32 v24, v144, v145
    v_cvt_pk_bf16_f32 v25, v146, v147
    v_cvt_pk_bf16_f32 v26, v148, v149
    v_cvt_pk_bf16_f32 v27, v150, v151
    s_cmp_ge_u32 s41, 28
    s_cbranch_scc1 L_p4_end
    s_cmp_eq_u32 s3, 0
    s_cbranch_scc1 L_stg_41
    buffer_store_dwordx4 v[24:27], v2, s[16:19], s79 offen offset:2048
    s_branch L_stj_42
L_stg_41:
    buffer_store_dwordx4 v[24:27], v2, s[16:19], s79 offen offset:2048 sc0 sc1
L_stj_42:
    s_branch L_p4_end
L_p4_idle:
    s_add_u32 m0, s68, 32768
    s_add_u32 s44, s69, 524288
    buffer_load_dwordx4 v11, s[28:31], s44 offen lds
    s_add_u32 m0, s68, 40960
    s_add_u32 s44, s69, 589824
    buffer_load_dwordx4 v11, s[28:31], s44 offen lds
    s_add_u32 m0, s68, 49152
    s_add_u32 s44, s69, 655360
    buffer_load_dwordx4 v11, s[28:31], s44 offen lds
    s_add_u32 m0, s68, 57344
    s_add_u32 s44, s69, 720896
    buffer_load_dwordx4 v11, s[28:31], s44 offen lds
    s_waitcnt vmcnt(0) lgkmcnt(0)
    s_barrier
    s_barrier
    s_add_u32 m0, s68, 65536
    s_add_u32 s44, s69, 786432
    buffer_load_dwordx4 v11, s[28:31], s44 offen lds
    s_add_u32 m0, s68, 73728
    s_add_u32 s44, s69, 851968
    buffer_load_dwordx4 v11, s[28:31], s44 offen lds
    s_add_u32 m0, s68, 81920
    s_add_u32 s44, s69, 917504
    buffer_load_dwordx4 v11, s[28:31], s44 offen lds
    s_add_u32 m0, s68, 90112
    s_add_u32 s44, s69, 983040
    buffer_load_dwordx4 v11, s[28:31], s44 offen lds
    s_add_u32 m0, s68, 98304
    s_add_u32 s44, s69, 1048576
    buffer_load_dwordx4 v11, s[28:31], s44 offen lds
    s_add_u32 m0, s68, 106496
    s_add_u32 s44, s69, 1114112
    buffer_load_dwordx4 v11, s[28:31], s44 offen lds
    s_add_u32 m0, s68, 114688
    s_add_u32 s44, s69, 1179648
    buffer_load_dwordx4 v11, s[28:31], s44 offen lds
    s_add_u32 m0, s68, 122880
    s_add_u32 s44, s69, 1245184
    buffer_load_dwordx4 v11, s[28:31], s44 offen lds
    s_add_u32 m0, s68, 131072
    s_add_u32 s44, s69, 1310720
    buffer_load_dwordx4 v11, s[28:31], s44 offen lds
L_p4_end:
    s_setprio 0
    s_lshl_b32 s44, s73, 11
    v_add_u32 v120, s44, v8
    v_add_u32 v121, s44, v9
    v_add_u32 v122, 0x10000, v120
    v_add_u32 v123, 0x10000, v121
    v_add_u32 v124, 0x20000, v120
    v_add_u32 v125, 0x20000, v121
    v_lshlrev_b32 v100, 16, v232
    v_and_b32 v101, 0xffff0000, v232
    v_lshlrev_b32 v102, 16, v233
    v_and_b32 v103, 0xffff0000, v233
    v_lshlrev_b32 v104, 16, v234
    v_and_b32 v105, 0xffff0000, v234
    v_lshlrev_b32 v106, 16, v235
    v_and_b32 v107, 0xffff0000, v235
    ds_read_b64_tr_b16 v[56:57], v120 offset:0
    ds_read_b64_tr_b16 v[58:59], v120 offset:1024
    ds_read_b64_tr_b16 v[60:61], v121 offset:0
    ds_read_b64_tr_b16 v[62:63], v121 offset:1024
    ds_read_b64_tr_b16 v[64:65], v120 offset:8192
    ds_read_b64_tr_b16 v[66:67], v120 offset:9216
    ds_read_b64_tr_b16 v[68:69], v121 offset:8192
    ds_read_b64_tr_b16 v[70:71], v121 offset:9216
    s_cmp_lg_u32 s42, 7
    s_cbranch_scc1 L_sig_43
    v_mov_b32 v4, s43
    v_lshlrev_b32 v3, 2, v1
    s_add_u32 s44, s36, 6144
    s_cmp_ge_u32 s41, 29
    s_cselect_b32 s44, 0x40000000, s44
    s_cmp_eq_u32 s3, 0
    s_cbranch_scc1 L_sgl_44
    s_mov_b64 exec, 1
    s_waitcnt vmcnt(0)
    s_barrier
    buffer_store_dword v4, v3, s[16:19], s44 offen
    s_mov_b64 exec, -1
    s_branch L_sig_43_j
L_sgl_44:
    s_mov_b64 exec, 1
    s_waitcnt vmcnt(0)
    s_barrier
    buffer_store_dword v4, v3, s[16:19], s44 offen sc0 sc1
    s_mov_b64 exec, -1
    s_branch L_sig_43_j
L_sig_43:
    s_waitcnt vmcnt(0)
    s_barrier
L_sig_43_j:
    s_cmp_lg_u32 s42, 7
    s_cbranch_scc1 L_pollskip_45
    s_add_u32 s44, s37, 6144
    s_mov_b64 exec, 0x1fffffff
    s_mov_b32 s45, 200000
L_poll_46:
    buffer_load_dword v4, v3, s[16:19], s44 offen sc0 sc1
    s_sub_u32 s45, s45, 1
    s_cbranch_scc1 L_poll_46_out
    s_waitcnt vmcnt(0)
    v_cmp_ne_u32 vcc, s43, v4
    s_cbranch_vccnz L_poll_46
L_poll_46_out:
    s_waitcnt vmcnt(0)
    s_mov_b64 exec, -1
L_pollskip_45:
    s_barrier
    buffer_load_dwordx4 v[128:131], v2, s[16:19], s85 offen sc0 sc1
    s_add_u32 s85, s85, 4096
    buffer_load_dwordx4 v[132:135], v2, s[16:19], s85 offen sc0 sc1
    s_add_u32 s85, s85, 4096
    buffer_load_dwordx4 v[136:139], v2, s[16:19], s85 offen sc0 sc1
    s_add_u32 s85, s85, 4096
    s_waitcnt vmcnt(2)
    v_mfma_f32_32x32x16_bf16 v[16:31], v[208:211], v[128:131], 0
    v_mfma_f32_32x32x16_bf16 v[32:47], v[212:215], v[128:131], 0
    buffer_load_dwordx4 v[128:131], v2, s[16:19], s85 offen sc0 sc1
    s_add_u32 s85, s85, 4096
    s_waitcnt vmcnt(2)
    v_mfma_f32_32x32x16_bf16 v[16:31], v[216:219], v[132:135], v[16:31]
    v_mfma_f32_32x32x16_bf16 v[32:47], v[220:223], v[132:135], v[32:47]
    buffer_load_dwordx4 v[132:135], v2, s[16:19], s85 offen sc0 sc1
    s_add_u32 s85, s85, 4096
    s_waitcnt vmcnt(2)
    v_mfma_f32_32x32x16_bf16 v[16:31], v[224:227], v[136:139], v[16:31]
    v_mfma_f32_32x32x16_bf16 v[32:47], v[228:231], v[136:139], v[32:47]
    buffer_load_dwordx4 v[136:139], v2, s[16:19], s85 offen sc0 sc1
    s_add_u32 s85, s85, 4096
    s_add_u32 m0, s68, 139264
    s_add_u32 s44, s69, 1376256
    buffer_load_dwordx4 v11, s[28:31], s44 offen lds
    s_waitcnt vmcnt(3)
    v_mfma_f32_32x32x16_bf16 v[16:31], v[80:83], v[128:131], v[16:31]
    v_mfma_f32_32x32x16_bf16 v[32:47], v[84:87], v[128:131], v[32:47]
    buffer_load_dwordx4 v[128:131], v2, s[16:19], s85 offen sc0 sc1
    s_add_u32 s85, s85, 4096
    s_waitcnt vmcnt(3) lgkmcnt(4)
    v_mfma_f32_32x32x16_bf16 v[16:31], v[56:59], v[132:135], v[16:31]
    ds_read_b64_tr_b16 v[48:49], v120 offset:16384
    ds_read_b64_tr_b16 v[50:51], v120 offset:17408
    v_mfma_f32_32x32x16_bf16 v[32:47], v[60:63], v[132:135], v[32:47]
    ds_read_b64_tr_b16 v[52:53], v121 offset:16384
    ds_read_b64_tr_b16 v[54:55], v121 offset:17408
    buffer_load_dwordx4 v[132:135], v2, s[16:19], s85 offen sc0 sc1
    s_add_u32 s85, s85, 4096
    s_waitcnt vmcnt(3) lgkmcnt(4)
    v_mfma_f32_32x32x16_bf16 v[16:31], v[64:67], v[136:139], v[16:31]
    ds_read_b64_tr_b16 v[56:57], v120 offset:24576
    ds_read_b64_tr_b16 v[58:59], v120 offset:25600
    v_mfma_f32_32x32x16_bf16 v[32:47], v[68:71], v[136:139], v[32:47]
    ds_read_b64_tr_b16 v[60:61], v121 offset:24576
    ds_read_b64_tr_b16 v[62:63], v121 offset:25600
    buffer_load_dwordx4 v[136:139], v2, s[16:19], s85 offen sc0 sc1
    s_add_u32 s85, s85, 4096
    s_waitcnt vmcnt(2) lgkmcnt(4)
    v_mfma_f32_32x32x16_bf16 v[16:31], v[48:51], v[128:131], v[16:31]
    ds_read_b64_tr_b16 v[64:65], v120 offset:32768
    ds_read_b64_tr_b16 v[66:67], v120 offset:33792
    v_mfma_f32_32x32x16_bf16 v[32:47], v[52:55], v[128:131], v[32:47]
    ds_read_b64_tr_b16 v[68:69], v121 offset:32768
    ds_read_b64_tr_b16 v[70:71], v121 offset:33792
    buffer_load_dwordx4 v[128:131], v2, s[16:19], s85 offen sc0 sc1
    s_add_u32 s85, s85, 4096
    s_waitcnt vmcnt(2) lgkmcnt(4)
    v_mfma_f32_32x32x16_bf16 v[16:31], v[56:59], v[132:135], v[16:31]
    ds_read_b64_tr_b16 v[48:49], v120 offset:40960
    ds_read_b64_tr_b16 v[50:51], v120 offset:41984
    v_mfma_f32_32x32x16_bf16 v[32:47], v[60:63], v[132:135], v[32:47]
    ds_read_b64_tr_b16 v[52:53], v121 offset:40960
    ds_read_b64_tr_b16 v[54:55], v121 offset:41984
    buffer_load_dwordx4 v[132:135], v2, s[16:19], s85 offen sc0 sc1
    s_add_u32 s85, s85, 4096
    s_waitcnt vmcnt(2) lgkmcnt(4)
    v_mfma_f32_32x32x16_bf16 v[16:31], v[64:67], v[136:139], v[16:31]
    ds_read_b64_tr_b16 v[56:57], v120 offset:49152
    ds_read_b64_tr_b16 v[58:59], v120 offset:50176
    v_mfma_f32_32x32x16_bf16 v[32:47], v[68:71], v[136:139], v[32:47]
    ds_read_b64_tr_b16 v[60:61], v121 offset:49152
    ds_read_b64_tr_b16 v[62:63], v121 offset:50176
    buffer_load_dwordx4 v[136:139], v2, s[16:19], s85 offen sc0 sc1
    s_add_u32 s85, s85, 4096
    s_waitcnt vmcnt(2) lgkmcnt(4)
    v_mfma_f32_32x32x16_bf16 v[16:31], v[48:51], v[128:131], v[16:31]
    ds_read_b64_tr_b16 v[64:65], v120 offset:57344
    ds_read_b64_tr_b16 v[66:67], v120 offset:58368
    v_mfma_f32_32x32x16_bf16 v[32:47], v[52:55], v[128:131], v[32:47]
    ds_read_b64_tr_b16 v[68:69], v121 offset:57344
    ds_read_b64_tr_b16 v[70:71], v121 offset:58368
    buffer_load_dwordx4 v[128:131], v2, s[16:19], s85 offen sc0 sc1
    s_add_u32 s85, s85, 4096
    s_waitcnt vmcnt(2) lgkmcnt(4)
    v_mfma_f32_32x32x16_bf16 v[16:31], v[56:59], v[132:135], v[16:31]
    ds_read_b64_tr_b16 v[48:49], v122 offset:0
    ds_read_b64_tr_b16 v[50:51], v122 offset:1024
    v_mfma_f32_32x32x16_bf16 v[32:47], v[60:63], v[132:135], v[32:47]
    ds_read_b64_tr_b16 v[52:53], v123 offset:0
    ds_read_b64_tr_b16 v[54:55], v123 offset:1024
    buffer_load_dwordx4 v[132:135], v2, s[16:19], s85 offen sc0 sc1
    s_add_u32 s85, s85, 4096
    s_waitcnt vmcnt(2) lgkmcnt(4)
    v_mfma_f32_32x32x16_bf16 v[16:31], v[64:67], v[136:139], v[16:31]
    ds_read_b64_tr_b16 v[56:57], v122 offset:8192
    ds_read_b64_tr_b16 v[58:59], v122 offset:9216
    v_mfma_f32_32x32x16_bf16 v[32:47], v[68:71], v[136:139], v[32:47]
    ds_read_b64_tr_b16 v[60:61], v123 offset:8192
    ds_read_b64_tr_b16 v[62:63], v123 offset:9216
    buffer_load_dwordx4 v[136:139], v2, s[16:19], s85 offen sc0 sc1
    s_add_u32 s85, s85, 4096
    s_waitcnt vmcnt(2) lgkmcnt(4)
    v_mfma_f32_32x32x16_bf16 v[16:31], v[48:51], v[128:131], v[16:31]
    ds_read_b64_tr_b16 v[64:65], v122 offset:16384
    ds_read_b64_tr_b16 v[66:67], v122 offset:17408
    v_mfma_f32_32x32x16_bf16 v[32:47], v[52:55], v[128:131], v[32:47]
    ds_read_b64_tr_b16 v[68:69], v123 offset:16384
    ds_read_b64_tr_b16 v[70:71], v123 offset:17408
    buffer_load_dwordx4 v[128:131], v2, s[16:19], s85 offen sc0 sc1
    s_add_u32 s85, s85, 4096
    s_waitcnt vmcnt(2) lgkmcnt(4)
    v_mfma_f32_32x32x16_bf16 v[16:31], v[56:59], v[132:135], v[16:31]
    ds_read_b64_tr_b16 v[48:49], v122 offset:24576
    ds_read_b64_tr_b16 v[50:51], v122 offset:25600
    v_mfma_f32_32x32x16_bf16 v[32:47], v[60:63], v[132:135], v[32:47]
    ds_read_b64_tr_b16 v[52:53], v123 offset:24576
    ds_read_b64_tr_b16 v[54:55], v123 offset:25600
    buffer_load_dwordx4 v[132:135], v2, s[16:19], s85 offen sc0 sc1
    s_add_u32 s85, s85, 4096
    s_waitcnt vmcnt(2) lgkmcnt(4)
    v_mfma_f32_32x32x16_bf16 v[16:31], v[64:67], v[136:139], v[16:31]
    ds_read_b64_tr_b16 v[56:57], v122 offset:32768
    ds_read_b64_tr_b16 v[58:59], v122 offset:33792
    v_mfma_f32_32x32x16_bf16 v[32:47], v[68:71], v[136:139], v[32:47]
    ds_read_b64_tr_b16 v[60:61], v123 offset:32768
    ds_read_b64_tr_b16 v[62:63], v123 offset:33792
    buffer_load_dwordx4 v[136:139], v2, s[16:19], s85 offen sc0 sc1
    s_add_u32 s85, s85, 4096
    s_waitcnt vmcnt(2) lgkmcnt(4)
    v_mfma_f32_32x32x16_bf16 v[16:31], v[48:51], v[128:131], v[16:31]
    ds_read_b64_tr_b16 v[64:65], v122 offset:40960
    ds_read_b64_tr_b16 v[66:67], v122 offset:41984
    v_mfma_f32_32x32x16_bf16 v[32:47], v[52:55], v[128:131], v[32:47]
    ds_read_b64_tr_b16 v[68:69], v123 offset:40960
    ds_read_b64_tr_b16 v[70:71], v123 offset:41984
    buffer_load_dwordx4 v[128:131], v2, s[16:19], s85 offen sc0 sc1
    s_add_u32 s85, s85, 4096
    s_waitcnt vmcnt(2) lgkmcnt(4)
    v_mfma_f32_32x32x16_bf16 v[16:31], v[56:59], v[132:135], v[16:31]
    ds_read_b64_tr_b16 v[48:49], v122 offset:49152
    ds_read_b64_tr_b16 v[50:51], v122 offset:50176
    v_mfma_f32_32x32x16_bf16 v[32:47], v[60:63], v[132:135], v[32:47]
    ds_read_b64_tr_b16 v[52:53], v123 offset:49152
    ds_read_b64_tr_b16 v[54:55], v123 offset:50176
    buffer_load_dwordx4 v[132:135], v2, s[16:19], s85 offen sc0 sc1
    s_add_u32 s85, s85, 4096
    s_waitcnt vmcnt(2) lgkmcnt(4)
    s_barrier
    v_mfma_f32_32x32x16_bf16 v[16:31], v[64:67], v[136:139], v[16:31]
    ds_read_b64_tr_b16 v[56:57], v122 offset:57344
    ds_read_b64_tr_b16 v[58:59], v122 offset:58368
    v_mfma_f32_32x32x16_bf16 v[32:47], v[68:71], v[136:139], v[32:47]
    ds_read_b64_tr_b16 v[60:61], v123 offset:57344
    ds_read_b64_tr_b16 v[62:63], v123 offset:58368
    buffer_load_dwordx4 v[136:139], v2, s[16:19], s85 offen sc0 sc1
    s_add_u32 s85, s85, 4096
    s_waitcnt vmcnt(2) lgkmcnt(4)
    v_mfma_f32_32x32x16_bf16 v[16:31], v[48:51], v[128:131], v[16:31]
    ds_read_b64_tr_b16 v[64:65], v124 offset:0
    ds_read_b64_tr_b16 v[66:67], v124 offset:1024
    v_mfma_f32_32x32x16_bf16 v[32:47], v[52:55], v[128:131], v[32:47]
    ds_read_b64_tr_b16 v[68:69], v125 offset:0
    ds_read_b64_tr_b16 v[70:71], v125 offset:1024
    s_add_u32 s85, s85, s87
    buffer_load_dwordx4 v[128:131], v2, s[16:19], s85 offen sc0 sc1
    s_add_u32 s85, s85, 4096
    s_waitcnt vmcnt(2) lgkmcnt(4)
    v_mfma_f32_32x32x16_bf16 v[16:31], v[56:59], v[132:135], v[16:31]
    ds_read_b64_tr_b16 v[48:49], v124 offset:8192
    ds_read_b64_tr_b16 v[50:51], v124 offset:9216
    v_mfma_f32_32x32x16_bf16 v[32:47], v[60:63], v[132:135], v[32:47]
    ds_read_b64_tr_b16 v[52:53], v125 offset:8192
    ds_read_b64_tr_b16 v[54:55], v125 offset:9216
    s_waitcnt vmcnt(1) lgkmcnt(4)
    v_mfma_f32_32x32x16_bf16 v[16:31], v[64:67], v[136:139], v[16:31]
    v_mfma_f32_32x32x16_bf16 v[32:47], v[68:71], v[136:139], v[32:47]
    s_waitcnt vmcnt(0) lgkmcnt(0)
    v_mfma_f32_32x32x16_bf16 v[16:31], v[48:51], v[128:131], v[16:31]
    v_mfma_f32_32x32x16_bf16 v[32:47], v[52:55], v[128:131], v[32:47]
    s_nop 7
    s_nop 1
    s_cmp_ge_u32 s73, 2
    s_cbranch_scc1 L_redhi_47
    ds_write_b128 v15, v[24:27] offset:2304
    ds_write_b128 v15, v[28:31] offset:3328
    ds_write_b128 v15, v[32:35] offset:0
    ds_write_b128 v15, v[36:39] offset:1024
    ds_write_b128 v15, v[40:43] offset:4608
    ds_write_b128 v15, v[44:47] offset:5632
    s_branch L_redj_48
L_redhi_47:
    ds_write_b128 v15, v[16:19] offset:2304
    ds_write_b128 v15, v[20:23] offset:3328
    ds_write_b128 v15, v[40:43] offset:0
    ds_write_b128 v15, v[44:47] offset:1024
    ds_write_b128 v15, v[32:35] offset:4608
    ds_write_b128 v15, v[36:39] offset:5632
    v_pk_mul_f32 v[16:17], v[24:25], 1.0 op_sel_hi:[1,0]
    v_pk_mul_f32 v[18:19], v[26:27], 1.0 op_sel_hi:[1,0]
    v_pk_mul_f32 v[20:21], v[28:29], 1.0 op_sel_hi:[1,0]
    v_pk_mul_f32 v[22:23], v[30:31], 1.0 op_sel_hi:[1,0]
L_redj_48:
    s_waitcnt lgkmcnt(0)
    s_barrier
    ds_read_b128 v[56:59], v12
    ds_read_b128 v[60:63], v12 offset:1024
    ds_read_b128 v[64:67], v13
    ds_read_b128 v[68:71], v13 offset:1024
    ds_read_b128 v[72:75], v14
    ds_read_b128 v[76:79], v14 offset:1024
    v_pk_add_f32 v[16:17], v[16:17], v[100:101]
    v_pk_add_f32 v[18:19], v[18:19], v[102:103]
    v_pk_add_f32 v[20:21], v[20:21], v[104:105]
    v_pk_add_f32 v[22:23], v[22:23], v[106:107]
    s_waitcnt lgkmcnt(4)
    v_pk_add_f32 v[16:17], v[16:17], v[56:57]
    v_pk_add_f32 v[18:19], v[18:19], v[58:59]
    v_pk_add_f32 v[20:21], v[20:21], v[60:61]
    v_pk_add_f32 v[22:23], v[22:23], v[62:63]
    s_waitcnt lgkmcnt(0)
    v_pk_add_f32 v[64:65], v[64:65], v[72:73]
    v_pk_add_f32 v[66:67], v[66:67], v[74:75]
    v_pk_add_f32 v[68:69], v[68:69], v[76:77]
    v_pk_add_f32 v[70:71], v[70:71], v[78:79]
    v_pk_add_f32 v[16:17], v[16:17], v[64:65]
    v_pk_add_f32 v[18:19], v[18:19], v[66:67]
    v_pk_add_f32 v[20:21], v[20:21], v[68:69]
    v_pk_add_f32 v[22:23], v[22:23], v[70:71]
    v_cvt_pk_bf16_f32 v48, v16, v17
    v_cvt_pk_bf16_f32 v49, v18, v19
    v_cvt_pk_bf16_f32 v50, v20, v21
    v_cvt_pk_bf16_f32 v51, v22, v23
    s_nop 1
    v_permlane32_swap_b32 v48, v50
    v_permlane32_swap_b32 v49, v51
    buffer_store_dwordx4 v[48:51], v249, s[32:35], 0 offen
L_done:
    s_endpgm
L_att_slow:
    s_mov_b32 s66, 1
    v_mov_b32 v194, 0xff800000
    s_add_u32 s47, s67, 0x80000
    s_add_u32 s46, s67, 0x40000
    s_mov_b32 s45, 0
    v_mov_b32 v176, 0
    v_mov_b32 v177, 0
    v_mov_b32 v178, 0
    v_mov_b32 v179, 0
    v_mov_b32 v180, 0
    v_mov_b32 v181, 0
    v_mov_b32 v182, 0
    v_mov_b32 v183, 0
    v_mov_b32 v184, 0
    v_mov_b32 v185, 0
    v_mov_b32 v186, 0
    v_mov_b32 v187, 0
    v_mov_b32 v188, 0
    v_mov_b32 v189, 0
    v_mov_b32 v190, 0
    v_mov_b32 v191, 0
L_att_sloop:
    buffer_load_dwordx4 v[32:35], v2, s[16:19], s46 offen sc0 sc1
    s_mov_b64 exec, s[90:91]
    buffer_load_dwordx4 v[44:47], v240, s[16:19], s47 offen sc0 sc1
    buffer_load_dwordx4 v[48:51], v240, s[16:19], s47 offen offset:512 sc0 sc1
    s_mov_b64 exec, -1
    s_add_u32 s46, s46, 1024
    s_add_u32 s47, s47, 1024
    s_waitcnt vmcnt(0)
    v_mfma_f32_32x32x16_bf16 v[68:83], v[32:35], v[16:19], 0
    s_nop 15
    v_max3_f32 v195, v68, v69, v194
    v_max3_f32 v195, v70, v71, v195
    v_max3_f32 v195, v72, v73, v195
    v_max3_f32 v195, v74, v75, v195
    v_max3_f32 v195, v76, v77, v195
    v_max3_f32 v195, v78, v79, v195
    v_max3_f32 v195, v80, v81, v195
    v_max3_f32 v195, v82, v83, v195
    v_mov_b32 v5, v195
    s_nop 1
    v_permlane32_swap_b32 v5, v195
    s_nop 1
    v_max_f32 v195, v5, v195
    v_sub_f32 v196, v194, v195
    v_exp_f32 v196, v196
    v_mov_b32 v194, v195
    v_sub_f32 v68, v68, v195
    v_sub_f32 v69, v69, v195
    v_sub_f32 v70, v70, v195
    v_sub_f32 v71, v71, v195
    v_sub_f32 v72, v72, v195
    v_sub_f32 v73, v73, v195
    v_sub_f32 v74, v74, v195
    v_sub_f32 v75, v75, v195
    v_sub_f32 v76, v76, v195
    v_sub_f32 v77, v77, v195
    v_sub_f32 v78, v78, v195
    v_sub_f32 v79, v79, v195
    v_sub_f32 v80, v80, v195
    v_sub_f32 v81, v81, v195
    v_sub_f32 v82, v82, v195
    v_sub_f32 v83, v83, v195
    v_exp_f32 v68, v68
    v_exp_f32 v69, v69
    v_exp_f32 v70, v70
    v_exp_f32 v71, v71
    v_exp_f32 v72, v72
    v_exp_f32 v73, v73
    v_exp_f32 v74, v74
    v_exp_f32 v75, v75
    v_exp_f32 v76, v76
    v_exp_f32 v77, v77
    v_exp_f32 v78, v78
    v_exp_f32 v79, v79
    v_exp_f32 v80, v80
    v_exp_f32 v81, v81
    v_exp_f32 v82, v82
    v_exp_f32 v83, v83
    v_mul_f32 v176, v176, v196
    v_mul_f32 v177, v177, v196
    v_mul_f32 v178, v178, v196
    v_mul_f32 v179, v179, v196
    v_mul_f32 v180, v180, v196
    v_mul_f32 v181, v181, v196
    v_mul_f32 v182, v182, v196
    v_mul_f32 v183, v183, v196
    v_mul_f32 v184, v184, v196
    v_mul_f32 v185, v185, v196
    v_mul_f32 v186, v186, v196
    v_mul_f32 v187, v187, v196
    v_mul_f32 v188, v188, v196
    v_mul_f32 v189, v189, v196
    v_mul_f32 v190, v190, v196
    v_mul_f32 v191, v191, v196
    s_nop 1
    v_smfmac_f32_32x32x32_bf16 v[176:191], v[44:47], v[68:75], v241
    v_smfmac_f32_32x32x32_bf16 v[176:191], v[48:51], v[76:83], v241
    s_add_u32 s45, s45, 1
    s_cmp_lt_u32 s45, 64
    s_nop 15
    s_cbranch_scc1 L_att_sloop
    s_branch L_att_fin
.section .rodata,"a"
.p2align 6
.amdhsa_kernel sequential_preLN__softmax_full_mha__glu_gated_reglu__prompt_kernel
  .amdhsa_next_free_vgpr 256
  .amdhsa_next_free_sgpr 100
  .amdhsa_accum_offset 256
  .amdhsa_group_segment_fixed_size 0
  .amdhsa_kernarg_size 80
  .amdhsa_user_sgpr_count 2
  .amdhsa_user_sgpr_kernarg_segment_ptr 1
  .amdhsa_system_sgpr_workgroup_id_x 1
.end_amdhsa_kernel
```
